```python
import torch

def _softmax(x, axis=-1):
    return torch.softmax(x, dim=axis)
def _gelu(x):
    return torch.nn.functional.gelu(x, approximate="tanh")
def _silu(x):
    return torch.nn.functional.silu(x)
def _sigmoid(x):
    return torch.sigmoid(x)
def _layernorm(x, axis=-1, eps=1e-5):
    m = x.mean(dim=axis, keepdim=True)
    v = x.var(dim=axis, keepdim=True, unbiased=False)
    return (x - m) / torch.sqrt(v + eps)
def _scatter_add(tgt, idx, src, axis=0):
    return tgt.clone().index_add_(axis, idx, src)
def _segment_sum(src, seg, n):
    out = torch.zeros((n,) + src.shape[1:], dtype=src.dtype)
    return out.index_add_(0, seg, src)
def _pad(x, pw):
    flat = tuple(v for pair in reversed(pw) for v in pair)
    return torch.nn.functional.pad(x, flat)

kernel_name = 'standalone__cheap_equivariant_egnn__graph'

def setup_inputs():

    _w = (lambda a: (lambda t: t.to(torch.bfloat16) if t.is_floating_point() else t)(torch.as_tensor(a)))
    N, deg, D, De = 25000, 32, 64, max(0, 1)
    E = N * deg
    return {
        "h": _w((lambda *s: torch.randn(*s, dtype=torch.bfloat16) * 0.2)(N, D)),
        "pos": _w((lambda *s: torch.randn(*s, dtype=torch.bfloat16) * 0.8)(N, 3)),
        "e_attr": _w((lambda *s: torch.randn(*s, dtype=torch.bfloat16) * 0.8)(E, De)),
        "src": _w((lambda lo, hi, *s: torch.randint(lo, hi, s))(0, N, E).to(torch.int64)),
        "dst": _w((lambda lo, hi, *s: torch.randint(lo, hi, s))(0, N, E).to(torch.int64)),
        "w_e": _w(0.1 * (lambda *s: torch.randn(*s, dtype=torch.bfloat16) * 0.8)(2 * D + 1 + De, D)),
        "w_x": _w(0.1 * (lambda *s: torch.randn(*s, dtype=torch.bfloat16) * 0.2)(D, 1)),
        "w_h": _w(0.1 * (lambda *s: torch.randn(*s, dtype=torch.bfloat16) * 0.2)(2 * D, D)),
    }

def reference(h, pos, e_attr, src, dst, w_e, w_x, w_h):
    N, D = h.shape[0], h.shape[1]
    diff = pos[dst] - pos[src]
    dist2 = torch.sum(diff * diff, axis=-1, keepdims=True)
    e_in = torch.concatenate([h[dst], h[src], dist2, e_attr], axis=-1)
    m_ij = _silu(e_in @ w_e)
    coord_scale = m_ij @ w_x
    pos_new = pos + _segment_sum(diff * coord_scale, dst, N)
    m_i = _segment_sum(m_ij, dst, N)
    h_new = h + _silu(torch.concatenate([h, m_i], axis=-1) @ w_h)
    return h_new, pos_new
```

```asm
; @launch grid=(256,1,1) block=(1024,1,1) lds=163712
.amdgcn_target "amdgcn-amd-amdhsa--gfx950"
.text
.globl standalone__cheap_equivariant_egnn__graph_kernel
.p2align 8
.type standalone__cheap_equivariant_egnn__graph_kernel,@function
standalone__cheap_equivariant_egnn__graph_kernel:
    s_cmp_ge_u32 s2, 256
    s_cbranch_scc1 K2_END
    s_load_dwordx8 s[4:11], s[0:1], 0
    s_load_dwordx8 s[64:71], s[0:1], 32
    s_load_dwordx2 s[14:15], s[0:1], 64
    s_load_dwordx2 s[16:17], s[0:1], 80
    v_lshrrev_b32 v1, 6, v0
    v_mov_b32 v61, v0
    s_getpc_b64 s[84:85]
F_PC:
    v_subrev_u32 v64, 832, v0
    v_lshlrev_b32 v64, 7, v64
    v_cmp_gt_u32 vcc, (K2_END-F_PC), v64
    s_nop 0
    s_and_saveexec_b64 s[76:77], vcc
    s_cbranch_execz F_NOPF
    global_load_dword v65, v64, s[84:85]
F_NOPF:
    s_mov_b64 exec, -1
    v_readfirstlane_b32 s19, v1
    s_and_b32 s18, s2, 7
    s_lshl_b32 s18, s18, 5
    s_lshr_b32 s3, s2, 3
    s_add_u32 s18, s18, s3
    s_mul_i32 s3, s18, 3128
    v_lshl_add_u32 v3, v0, 2, s3
    v_cmp_gt_u32 vcc, 782, v0
    s_mov_b32 s54, 800000
    v_cmp_gt_u32 s[76:77], s54, v3
    v_lshlrev_b32 v4, 2, v3
    v_lshlrev_b32 v5, 1, v3
    s_and_b64 s[76:77], s[76:77], vcc
    v_and_b32 v60, 63, v0
    s_mul_i32 s23, s18, 98
    s_cmp_gt_u32 s19, 12
    s_cbranch_scc1 F_TAB0
    s_waitcnt lgkmcnt(0)
    s_mov_b64 exec, s[76:77]
    global_load_dwordx4 v[8:11], v4, s[64:65]
    s_mov_b64 exec, -1
    v_lshlrev_b32 v62, 4, v61
    v_mov_b64 v[36:37], 0
    v_mov_b64 v[38:39], 0
    ds_write_b128 v62, v[36:39] offset:0
    ds_write_b128 v62, v[36:39] offset:13312
    ds_write_b128 v62, v[36:39] offset:20480
    v_add_u32 v40, 83328, v62
    ds_write_b128 v40, v[36:39]
    ds_write_b128 v40, v[36:39] offset:13312
    ds_write_b128 v40, v[36:39] offset:17664
    s_cmp_eq_u32 s19, 1
    s_cbranch_scc1 F_ZCNT
    s_cmp_lg_u32 s19, 2
    s_cbranch_scc1 F_Z1
    v_and_b32 v40, 1, v60
    v_lshlrev_b32 v40, 4, v40
    v_mov_b32 v41, 0x3f80
    v_lshlrev_b32 v40, v40, v41
    v_bfe_u32 v41, v60, 1, 2
    v_cmp_eq_u32 s[24:25], 0, v41
    v_cmp_eq_u32 s[26:27], 1, v41
    v_cmp_eq_u32 s[28:29], 2, v41
    v_cmp_eq_u32 s[30:31], 3, v41
    v_cndmask_b32 v52, 0, v40, s[24:25]
    v_cndmask_b32 v53, 0, v40, s[26:27]
    v_cndmask_b32 v54, 0, v40, s[28:29]
    v_cndmask_b32 v55, 0, v40, s[30:31]
    v_lshlrev_b32 v41, 5, v60
    ds_write_b128 v41, v[52:55] offset:44928
    ds_write_b128 v41, v[52:55] offset:46976
    s_branch F_Z1
F_ZCNT:
    v_and_b32 v40, 15, v60
    v_subrev_u32 v41, 2, v40
    v_mul_u32_u24 v42, 1088, v41
    v_mul_u32_u24 v41, 1280, v40
    v_add_u32 v41, 15232, v41
    v_cmp_gt_u32 vcc, 2, v40
    s_nop 1
    v_cndmask_b32 v42, v42, v41, vcc
    v_cndmask_b32_e64 v41, 0, 1, vcc
    v_lshlrev_b32 v41, 8, v41
    s_mov_b32 exec_lo, 0
    s_mov_b32 exec_hi, 0xffff0000
    v_add_u32 v42, v42, v41
    v_add_u32 v42, 1024, v42
    s_mov_b32 exec_lo, 0
    s_mov_b32 exec_hi, 0xffff
    v_lshlrev_b32 v42, 2, v42
    v_sub_u32 v42, v40, v42
    s_mov_b32 exec_lo, 0xffff0000
    s_mov_b32 exec_hi, 0
    v_mov_b32 v42, 0
    s_mov_b64 exec, -1
    v_lshlrev_b32 v41, 2, v60
    ds_write_b32 v41, v42 offset:35584
    s_mov_b32 exec_hi, 0
    ds_write_b32 v41, v42 offset:35840
    s_mov_b64 exec, -1
    s_branch F_Z1
F_TAB0:
    v_lshlrev_b32 v62, 4, v61
    v_and_b32 v35, 3, v60
    s_waitcnt lgkmcnt(0)
    s_mov_b64 s[78:79], 0
    v_mov_b32 v29, 0
    s_cmp_eq_u32 s19, 13
    s_cbranch_scc1 F_POSLD_DONE
    v_subrev_u32 v28, 896, v61
    v_add_u32 v29, s23, v28
    v_cmp_gt_u32 vcc, 98, v28
    s_mov_b32 s3, 25000
    v_cmp_gt_u32 s[78:79], s3, v29
    v_mul_u32_u24 v22, 6, v29
    s_and_b64 s[78:79], s[78:79], vcc
    s_mov_b64 exec, s[78:79]
    global_load_ushort v24, v22, s[6:7] offset:0
    global_load_ushort v25, v22, s[6:7] offset:2
    global_load_ushort v26, v22, s[6:7] offset:4
    s_mov_b64 exec, -1
F_POSLD_DONE:
    v_lshrrev_b32 v41, 3, v60
    v_xor_b32 v42, v41, v60
    v_and_b32 v42, 7, v42
    s_lshl3_add_u32 s3, s19, s23
    s_lshl_b32 s3, s3, 7
    v_lshl_add_u32 v52, v41, 7, s3
    v_min_u32 v52, 3199872, v52
    v_lshl_add_u32 v52, v42, 4, v52
    s_and_b32 s54, s19, 11
    s_lshl_b32 s56, s54, 11
    s_lshr_b32 s54, s19, 3
    s_lshl_b32 s54, s54, 13
    s_sub_u32 s56, s56, s54
    s_bfe_u32 s54, s19, 0x10002
    s_lshl_b32 s54, s54, 6
    s_add_u32 s56, s56, s54
    v_lshrrev_b32 v53, 2, v60
    v_lshl_add_u32 v53, v53, 7, s56
    v_lshl_add_u32 v53, v35, 4, v53
    s_lshl_b32 s3, s19, 10
    s_add_u32 m0, s3, 114560
    global_load_dwordx4 v[44:47], v62, s[70:71]
    global_load_lds_dwordx4 v52, s[4:5]
    s_add_u32 m0, s3, 49024
    s_nop 0
    global_load_lds_dwordx4 v53, s[66:67]
    s_cmp_lg_u32 s19, 15
    s_cbranch_scc1 F_SIDE0_DONE
    v_and_b32 v23, 31, v60
    v_lshlrev_b32 v22, 1, v23
    v_add_u32 v22, 0x4000, v22
    global_load_ushort v0, v22, s[66:67] offset:0
    global_load_ushort v1, v22, s[66:67] offset:64
    global_load_ushort v2, v22, s[66:67] offset:128
    global_load_ushort v3, v22, s[66:67] offset:192
    v_lshrrev_b32 v22, 3, v23
    v_lshlrev_b32 v22, 5, v22
    v_bfe_u32 v31, v23, 1, 1
    v_lshl_add_u32 v22, v31, 4, v22
    v_bfe_u32 v31, v23, 2, 1
    v_lshl_add_u32 v22, v31, 3, v22
    v_and_b32 v31, 1, v23
    v_lshl_add_u32 v22, v31, 2, v22
    global_load_dword v30, v22, s[68:69]
F_SIDE0_DONE:
    v_mov_b32 v36, 0x7fc07fc0
    v_lshlrev_b32 v37, 2, v60
    v_add_u32 v37, 114304, v37
    ds_write_b32 v37, v36
F_Z1:
    v_and_b32 v35, 3, v60
    s_waitcnt lgkmcnt(0)
    s_mov_b32 s3, 14942208
    s_load_dword s72, s[16:17], s3
    s_barrier
    s_cmp_gt_u32 s19, 12
    s_cbranch_scc1 F_NOSRC
    s_mov_b64 exec, s[76:77]
    global_load_dwordx4 v[12:15], v4, s[10:11]
    global_load_dwordx2 v[16:17], v5, s[8:9]
    s_mov_b64 exec, -1
F_NOSRC:
    v_lshrrev_b32 v40, 5, v60
    v_bfe_u32 v41, v60, 2, 2
    v_lshl_add_u32 v41, v40, 3, v41
    v_lshl_add_u32 v41, v41, 3, v35
    v_bfe_u32 v43, v60, 4, 1
    v_lshl_add_u32 v59, v43, 2, v41
    s_cmp_gt_u32 s19, 12
    s_cbranch_scc1 F_TAB1
    v_lshrrev_b32 v41, 3, v60
    v_xor_b32 v42, v41, v60
    v_and_b32 v42, 7, v42
    s_lshl3_add_u32 s3, s19, s23
    s_lshl_b32 s3, s3, 7
    v_lshl_add_u32 v52, v41, 7, s3
    v_min_u32 v52, 3199872, v52
    v_lshl_add_u32 v52, v42, 4, v52
    s_and_b32 s54, s19, 11
    s_lshl_b32 s56, s54, 11
    s_lshr_b32 s54, s19, 3
    s_lshl_b32 s54, s54, 13
    s_sub_u32 s56, s56, s54
    s_bfe_u32 s54, s19, 0x10002
    s_lshl_b32 s54, s54, 6
    s_add_u32 s56, s56, s54
    v_lshrrev_b32 v53, 2, v60
    v_lshl_add_u32 v53, v53, 7, s56
    v_lshl_add_u32 v53, v35, 4, v53
    s_and_b32 s54, s19, 1
    s_lshl_b32 s54, s54, 12
    s_and_b32 s56, s19, 2
    s_lshl_b32 s56, s56, 13
    s_add_u32 s54, s54, s56
    s_add_u32 s54, s54, 49024
    v_lshl_add_u32 v63, v59, 3, s54
    v_lshrrev_b32 v40, 5, v60
    v_xor_b32 v41, v40, v60
    v_and_b32 v41, 7, v41
    v_and_b32 v42, 31, v60
    s_lshr_b32 s3, s19, 2
    s_lshl_b32 s3, s3, 12
    s_add_u32 s3, s3, 114560
    v_lshl_add_u32 v43, v42, 7, s3
    v_lshl_add_u32 v4, v41, 4, v43
    v_xor_b32 v5, 32, v4
    v_xor_b32 v6, 64, v4
    v_xor_b32 v7, 96, v4
    s_and_b32 s54, s19, 7
    s_lshl_b32 s54, s54, 9
    s_mov_b32 s56, 65408
    s_cmp_ge_u32 s19, 8
    s_cselect_b32 s56, 36736, s56
    s_add_u32 s54, s54, s56
    v_lshl_add_u32 v58, v60, 3, s54
    v_lshrrev_b32 v56, 3, v61
    s_lshl_b32 s3, s18, 7
    s_add_u32 s3, s3, 4194304
    v_and_b32 v57, 7, v61
    v_lshl_add_u32 v57, v57, 4, s3
    s_mov_b32 s3, 32896
    v_mad_u32_u24 v56, v56, s3, v57
    s_mul_i32 s3, s18, 25088
    s_add_u32 s3, s3, 15728640
    v_add_u32 v57, s3, v62
    s_mov_b32 s83, 43826197
    s_mov_b32 s84, -98
    v_mov_b32 v19, 1
    s_mov_b64 exec, s[76:77]
    s_waitcnt vmcnt(2)
    v_mul_hi_u32 v20, v8, s83
    v_mul_hi_u32 v21, v9, s83
    v_mul_hi_u32 v22, v10, s83
    v_mul_hi_u32 v23, v11, s83
    v_mad_i32_i24 v8, v20, s84, v8
    v_lshlrev_b32 v20, 2, v20
    ds_add_rtn_u32 v24, v20, v19 offset:32768
    v_mad_i32_i24 v9, v21, s84, v9
    v_lshlrev_b32 v21, 2, v21
    ds_add_rtn_u32 v25, v21, v19 offset:32768
    v_mad_i32_i24 v10, v22, s84, v10
    v_lshlrev_b32 v22, 2, v22
    ds_add_rtn_u32 v26, v22, v19 offset:32768
    v_mad_i32_i24 v11, v23, s84, v11
    v_lshlrev_b32 v23, 2, v23
    ds_add_rtn_u32 v27, v23, v19 offset:32768
    v_and_b32 v28, 15, v8
    v_lshrrev_b32 v8, 4, v8
    v_lshlrev_b32 v29, 12, v28
    v_lshl_or_b32 v29, v8, 9, v29
    v_lshlrev_b32 v48, 5, v20
    v_lshlrev_b32 v20, 1, v20
    v_add_u32 v20, 73600, v20
    v_and_b32 v30, 15, v9
    v_lshrrev_b32 v9, 4, v9
    v_lshlrev_b32 v31, 12, v30
    v_lshl_or_b32 v31, v9, 9, v31
    v_lshlrev_b32 v49, 5, v21
    v_lshlrev_b32 v21, 1, v21
    v_add_u32 v21, 73600, v21
    v_and_b32 v32, 15, v10
    v_lshrrev_b32 v10, 4, v10
    v_lshlrev_b32 v33, 12, v32
    v_lshl_or_b32 v33, v10, 9, v33
    v_lshlrev_b32 v50, 5, v22
    v_lshlrev_b32 v22, 1, v22
    v_add_u32 v22, 73600, v22
    v_and_b32 v34, 15, v11
    v_lshrrev_b32 v11, 4, v11
    v_lshlrev_b32 v35, 12, v34
    v_lshl_or_b32 v35, v11, 9, v35
    v_lshlrev_b32 v51, 5, v23
    v_lshlrev_b32 v23, 1, v23
    v_add_u32 v23, 73600, v23
    s_mov_b64 exec, -1
    s_lshl_b32 s3, s19, 10
    s_add_u32 m0, s3, 114560
    global_load_dwordx4 v[44:47], v62, s[70:71]
    global_load_lds_dwordx4 v52, s[4:5]
    s_add_u32 m0, s3, 49024
    s_nop 0
    global_load_lds_dwordx4 v53, s[66:67]
    s_mov_b64 exec, s[76:77]
    s_waitcnt lgkmcnt(0)
    s_barrier
    v_lshlrev_b32 v8, 4, v24
    v_cmp_gt_u32 s[24:25], 16, v24
    v_lshlrev_b32 v9, 4, v25
    v_cmp_gt_u32 s[26:27], 16, v25
    v_lshlrev_b32 v10, 4, v26
    v_cmp_gt_u32 s[28:29], 16, v26
    v_lshlrev_b32 v11, 4, v27
    v_cmp_gt_u32 s[30:31], 16, v27
    s_mov_b32 s83, 0xffff0000
    s_barrier
    ds_read_b64 v[36:37], v20
    ds_read_b64 v[38:39], v21
    ds_read_b64 v[40:41], v22
    ds_read_b64 v[42:43], v23
    s_waitcnt lgkmcnt(3)
    v_bfe_u32 v36, v36, v8, 9
    v_cndmask_b32 v37, v37, v48, s[24:25]
    v_or_b32 v29, v29, v36
    v_lshl_add_u32 v37, v24, 3, v37
    s_waitcnt lgkmcnt(2)
    v_bfe_u32 v38, v38, v9, 9
    v_cndmask_b32 v39, v39, v49, s[26:27]
    v_or_b32 v31, v31, v38
    v_lshl_add_u32 v39, v25, 3, v39
    s_waitcnt lgkmcnt(1)
    v_bfe_u32 v40, v40, v10, 9
    v_cndmask_b32 v41, v41, v50, s[28:29]
    v_or_b32 v33, v33, v40
    v_lshl_add_u32 v41, v26, 3, v41
    s_waitcnt lgkmcnt(0)
    v_bfe_u32 v42, v42, v11, 9
    v_cndmask_b32 v43, v43, v51, s[30:31]
    v_or_b32 v35, v35, v42
    v_lshl_add_u32 v43, v27, 3, v43
    s_waitcnt vmcnt(3)
    v_lshlrev_b32 v28, 2, v12
    v_lshl_or_b32 v29, v16, 16, v29
    ds_write_b64 v37, v[28:29]
    v_lshlrev_b32 v30, 2, v13
    v_and_or_b32 v31, v16, s83, v31
    ds_write_b64 v39, v[30:31]
    v_lshlrev_b32 v32, 2, v14
    v_lshl_or_b32 v33, v17, 16, v33
    ds_write_b64 v41, v[32:33]
    v_lshlrev_b32 v34, 2, v15
    v_and_or_b32 v35, v17, s83, v35
    ds_write_b64 v43, v[34:35]
    s_mov_b64 exec, -1
    s_branch F_JOIN_D
F_TAB1:
    s_cmp_eq_u32 s19, 13
    s_cbranch_scc1 F_EPOS_DONE
    s_cmp_eq_u32 s19, 14
    s_cbranch_scc1 F_EPOS_W14
    s_waitcnt vmcnt(8)
    s_branch F_EPOS_GO
F_EPOS_W14:
    s_waitcnt vmcnt(3)
F_EPOS_GO:
    s_mov_b64 exec, s[78:79]
    s_mov_b32 s3, 13631488
    v_lshlrev_b32 v24, 16, v24
    v_lshlrev_b32 v25, 16, v25
    v_lshlrev_b32 v26, 16, v26
    v_lshrrev_b32 v22, 4, v28
    v_lshlrev_b32 v27, 3, v22
    v_lshl_add_u32 v29, v29, 4, s3
    global_store_dwordx4 v29, v[24:27], s[16:17] sc1
    v_and_b32 v28, 15, v28
    v_lshl_add_u32 v28, v28, 3, v22
    v_lshlrev_b32 v28, 5, v28
    ds_write_b128 v28, v[24:27] offset:44944
    s_mov_b64 exec, -1
F_EPOS_DONE:
    s_sub_u32 s55, s19, 13
    s_lshl_b32 s3, s55, 5
    s_add_u32 s3, s3, s23
    s_lshl_b32 s75, s3, 7
    s_lshl_b32 s54, s55, 12
    s_add_u32 s54, s54, 114560
    v_lshlrev_b32 v51, 3, v59
    v_add_u32 v51, 57216, v51
    v_lshl_add_u32 v49, v40, 9, s75
    v_and_b32 v42, 31, v60
    v_lshl_add_u32 v49, v42, 2, v49
    v_xor_b32 v41, v40, v60
    v_and_b32 v41, 7, v41
    v_lshl_add_u32 v43, v42, 7, s54
    v_lshl_add_u32 v32, v41, 4, v43
    v_xor_b32 v33, 32, v32
    v_xor_b32 v34, 64, v32
    v_xor_b32 v35, 96, v32
    s_mov_b32 s83, 0xffff0000
    s_mov_b32 s84, 0x80000000
    s_and_b32 s54, s19, 7
    s_lshl_b32 s54, s54, 9
    s_mov_b32 s56, 65408
    s_cmp_ge_u32 s19, 8
    s_cselect_b32 s56, 36736, s56
    s_add_u32 s54, s54, s56
    v_lshl_add_u32 v58, v60, 3, s54
    v_lshrrev_b32 v56, 3, v61
    s_lshl_b32 s3, s18, 7
    s_add_u32 s3, s3, 4194304
    v_and_b32 v57, 7, v61
    v_lshl_add_u32 v57, v57, 4, s3
    s_mov_b32 s3, 32896
    v_mad_u32_u24 v56, v56, s3, v57
    s_mul_i32 s3, s18, 25088
    s_add_u32 s3, s3, 15728640
    v_add_u32 v57, s3, v62
    v_subrev_u32 v12, 832, v61
    v_lshlrev_b32 v12, 3, v12
    s_mov_b32 s3, 73600
    v_lshl_add_u32 v13, v12, 1, s3
    v_mov_b64 v[18:19], 0
    v_mov_b32 v20, 0
    s_mov_b32 s3, 89088
    s_setprio 3
    s_waitcnt lgkmcnt(0)
    s_barrier
    s_cmp_eq_u32 s19, 15
    s_cbranch_scc1 F_NOINFO
    ds_read_b64 v[14:15], v12 offset:32768
    s_waitcnt lgkmcnt(0)
    v_add_u32 v14, 15, v14
    v_lshrrev_b32 v14, 4, v14
    v_sub_u32 v14, v14, 1 clamp
    v_add_u32 v15, 15, v15
    v_lshrrev_b32 v15, 4, v15
    v_sub_u32 v15, v15, 1 clamp
    v_add_u32 v16, v14, v15
    v_cmp_lt_u32 vcc, 0, v16
    s_nop 0
    s_mov_b64 exec, vcc
    ds_add_rtn_u32 v18, v20, v16 offset:35904
    s_mov_b64 exec, -1
    v_lshlrev_b32 v16, 1, v14
    v_add_u32 v16, 0x10001, v16
    v_lshlrev_b32 v17, 1, v15
    v_add_u32 v17, 0x10001, v17
    s_waitcnt lgkmcnt(0)
    v_add_u32 v19, v18, v14
    v_lshl_or_b32 v8, v18, 17, v16
    v_lshl_add_u32 v9, v18, 7, s3
    v_lshl_or_b32 v10, v19, 17, v17
    v_lshl_add_u32 v11, v19, 7, s3
    ds_write_b128 v13, v[8:11]
    s_waitcnt lgkmcnt(0)
F_NOINFO:
    s_barrier
    s_waitcnt vmcnt(0)
F_JOIN_D:
    s_mov_b32 s60, s16
    s_mov_b32 s61, s17
    s_mov_b32 s62, 3200000
    s_mov_b32 s63, 0x20000
    v_mov_b32 v36, 0
    s_mov_b32 s82, 0
    s_add_u32 s72, s72, 0x5e6a0000
    s_and_b32 s72, s72, 0xfffe0000
    v_add_u32 v55, 4210688, v56
    v_add_u32 v54, 89216, v62
    v_mov_b64 v[40:41], 0
    s_waitcnt lgkmcnt(0)
    s_barrier
    ds_read_b128 v[8:11], v62 offset:0
    ds_read_b128 v[12:15], v62 offset:16384
    ds_read_b32 v43, v36 offset:35904
    ds_read_b128 v[16:19], v54
    s_waitcnt lgkmcnt(3)
    v_xor_b32 v8, s72, v8
    v_xor_b32 v10, s72, v10
    global_store_dwordx4 v56, v[8:11], s[16:17] sc1
    s_waitcnt lgkmcnt(2)
    v_xor_b32 v12, s72, v12
    v_xor_b32 v14, s72, v14
    global_store_dwordx4 v55, v[12:15], s[16:17] sc1
    s_waitcnt lgkmcnt(0)
    v_lshlrev_b32 v43, 3, v43
    v_cmp_gt_u32 vcc, v43, v61
    v_xor_b32 v16, s72, v16
    v_xor_b32 v18, s72, v18
    s_and_b64 exec, exec, vcc
    s_cbranch_execz F_POOL_DONEA
    global_store_dwordx4 v57, v[16:19], s[16:17] sc1
    s_mov_b32 s82, 1
    ds_write_b64 v54, v[40:41]
    ds_write_b64 v54, v[40:41] offset:8
    v_add_u32 v50, 1024, v61
    v_cmp_gt_u32 vcc, v43, v50
    s_nop 0
    s_and_b64 exec, exec, vcc
    s_cbranch_execz F_POOL_DONEA
    ds_read_b128 v[20:23], v54 offset:16384
    ds_write_b64 v54, v[40:41] offset:16384
    ds_write_b64 v54, v[40:41] offset:16392
    v_add_u32 v57, 0x4000, v57
    s_waitcnt lgkmcnt(0)
    v_xor_b32 v20, s72, v20
    v_xor_b32 v22, s72, v22
    global_store_dwordx4 v57, v[20:23], s[16:17] sc1
F_POOL_DONEA:
    s_mov_b64 exec, -1
    s_cmp_eq_u32 s82, 0
    s_cbranch_scc1 F_E0
    s_waitcnt vmcnt(3)
    s_branch F_E1
F_E0:
    s_waitcnt vmcnt(2)
F_E1:
    s_mov_b32 s3, 0x05040100
    s_mov_b32 s52, 0x07060302
    v_perm_b32 v52, v45, v44, s3
    v_perm_b32 v53, v47, v46, s3
    v_perm_b32 v54, v45, v44, s52
    v_perm_b32 v55, v47, v46, s52
    ds_write_b64 v58, v[52:53]
    ds_write_b64 v58, v[54:55] offset:4096
    s_waitcnt lgkmcnt(0)
    s_barrier
    s_cmp_lt_u32 s19, 13
    s_cbranch_scc1 F_NOB
    s_cmp_eq_u32 s19, 13
    s_cbranch_scc1 F_B13
    ds_read_b128 v[64:67], v32
    ds_read_b128 v[68:71], v33
    ds_read_b128 v[72:75], v34
    ds_read_b128 v[76:79], v35
    ds_read_b64_tr_b16 v[36:37], v51 offset:0
    ds_read_b64_tr_b16 v[38:39], v51 offset:256
    ds_read_b64_tr_b16 v[40:41], v51 offset:4096
    ds_read_b64_tr_b16 v[42:43], v51 offset:4352
    ds_read_b64_tr_b16 v[52:53], v51 offset:1024
    ds_read_b64_tr_b16 v[54:55], v51 offset:1280
    s_waitcnt lgkmcnt(4)
    v_mfma_f32_32x32x16_bf16 v[96:111], v[64:67], v[36:39], 0
    ds_read_b64_tr_b16 v[36:37], v51 offset:5120
    ds_read_b64_tr_b16 v[38:39], v51 offset:5376
    s_waitcnt lgkmcnt(4)
    v_mfma_f32_32x32x16_bf16 v[112:127], v[64:67], v[40:43], 0
    ds_read_b64_tr_b16 v[40:41], v51 offset:2048
    ds_read_b64_tr_b16 v[42:43], v51 offset:2304
    s_waitcnt lgkmcnt(4)
    v_mfma_f32_32x32x16_bf16 v[96:111], v[68:71], v[52:55], v[96:111]
    ds_read_b64_tr_b16 v[52:53], v51 offset:6144
    ds_read_b64_tr_b16 v[54:55], v51 offset:6400
    s_waitcnt lgkmcnt(4)
    v_mfma_f32_32x32x16_bf16 v[112:127], v[68:71], v[36:39], v[112:127]
    ds_read_b64_tr_b16 v[36:37], v51 offset:3072
    ds_read_b64_tr_b16 v[38:39], v51 offset:3328
    s_waitcnt lgkmcnt(4)
    v_mfma_f32_32x32x16_bf16 v[96:111], v[72:75], v[40:43], v[96:111]
    ds_read_b64_tr_b16 v[40:41], v51 offset:7168
    ds_read_b64_tr_b16 v[42:43], v51 offset:7424
    s_waitcnt lgkmcnt(4)
    v_mfma_f32_32x32x16_bf16 v[112:127], v[72:75], v[52:55], v[112:127]
    s_waitcnt lgkmcnt(2)
    v_mfma_f32_32x32x16_bf16 v[96:111], v[76:79], v[36:39], v[96:111]
    s_waitcnt lgkmcnt(0)
    v_mfma_f32_32x32x16_bf16 v[112:127], v[76:79], v[40:43], v[112:127]
    s_branch F_B_DONE
F_B13:
    ds_read_b128 v[64:67], v32
    ds_read_b128 v[80:83], v32 offset:12288
    ds_read_b128 v[68:71], v33
    ds_read_b128 v[84:87], v33 offset:12288
    ds_read_b128 v[72:75], v34
    ds_read_b128 v[88:91], v34 offset:12288
    ds_read_b128 v[76:79], v35
    ds_read_b128 v[92:95], v35 offset:12288
    ds_read_b64_tr_b16 v[36:37], v51 offset:0
    ds_read_b64_tr_b16 v[38:39], v51 offset:256
    ds_read_b64_tr_b16 v[40:41], v51 offset:4096
    ds_read_b64_tr_b16 v[42:43], v51 offset:4352
    ds_read_b64_tr_b16 v[52:53], v51 offset:1024
    ds_read_b64_tr_b16 v[54:55], v51 offset:1280
    s_waitcnt lgkmcnt(4)
    v_mfma_f32_32x32x16_bf16 v[96:111], v[64:67], v[36:39], 0
    v_mfma_f32_32x32x16_bf16 v[0:15], v[80:83], v[36:39], 0
    ds_read_b64_tr_b16 v[36:37], v51 offset:5120
    ds_read_b64_tr_b16 v[38:39], v51 offset:5376
    s_waitcnt lgkmcnt(4)
    v_mfma_f32_32x32x16_bf16 v[112:127], v[64:67], v[40:43], 0
    v_mfma_f32_32x32x16_bf16 v[16:31], v[80:83], v[40:43], 0
    ds_read_b64_tr_b16 v[40:41], v51 offset:2048
    ds_read_b64_tr_b16 v[42:43], v51 offset:2304
    s_waitcnt lgkmcnt(4)
    v_mfma_f32_32x32x16_bf16 v[96:111], v[68:71], v[52:55], v[96:111]
    v_mfma_f32_32x32x16_bf16 v[0:15], v[84:87], v[52:55], v[0:15]
    ds_read_b64_tr_b16 v[52:53], v51 offset:6144
    ds_read_b64_tr_b16 v[54:55], v51 offset:6400
    s_waitcnt lgkmcnt(4)
    v_mfma_f32_32x32x16_bf16 v[112:127], v[68:71], v[36:39], v[112:127]
    v_mfma_f32_32x32x16_bf16 v[16:31], v[84:87], v[36:39], v[16:31]
    ds_read_b64_tr_b16 v[36:37], v51 offset:3072
    ds_read_b64_tr_b16 v[38:39], v51 offset:3328
    s_waitcnt lgkmcnt(4)
    v_mfma_f32_32x32x16_bf16 v[96:111], v[72:75], v[40:43], v[96:111]
    v_mfma_f32_32x32x16_bf16 v[0:15], v[88:91], v[40:43], v[0:15]
    ds_read_b64_tr_b16 v[40:41], v51 offset:7168
    ds_read_b64_tr_b16 v[42:43], v51 offset:7424
    s_waitcnt lgkmcnt(4)
    v_mfma_f32_32x32x16_bf16 v[112:127], v[72:75], v[52:55], v[112:127]
    v_mfma_f32_32x32x16_bf16 v[16:31], v[88:91], v[52:55], v[16:31]
    s_waitcnt lgkmcnt(2)
    v_mfma_f32_32x32x16_bf16 v[96:111], v[76:79], v[36:39], v[96:111]
    v_mfma_f32_32x32x16_bf16 v[0:15], v[92:95], v[36:39], v[0:15]
    s_waitcnt lgkmcnt(0)
    v_mfma_f32_32x32x16_bf16 v[112:127], v[76:79], v[40:43], v[112:127]
    v_mfma_f32_32x32x16_bf16 v[16:31], v[92:95], v[40:43], v[16:31]
    s_nop 7
F_B_DONE:
    s_and_b32 s54, s19, 1
    s_lshl_b32 s54, s54, 12
    s_and_b32 s56, s19, 2
    s_lshl_b32 s56, s56, 13
    s_add_u32 s54, s54, s56
    s_add_u32 s54, s54, 49024
    v_lshl_add_u32 v63, v59, 3, s54
    v_lshrrev_b32 v40, 5, v60
    v_xor_b32 v41, v40, v60
    v_and_b32 v41, 7, v41
    v_and_b32 v42, 31, v60
    s_lshr_b32 s3, s19, 2
    s_lshl_b32 s3, s3, 12
    s_add_u32 s3, s3, 114560
    v_lshl_add_u32 v43, v42, 7, s3
    v_lshl_add_u32 v4, v41, 4, v43
    v_xor_b32 v5, 32, v4
    v_xor_b32 v6, 64, v4
    v_xor_b32 v7, 96, v4
F_NOB:
    ds_read_b128 v[64:67], v4
    ds_read_b64_tr_b16 v[80:81], v63 offset:0
    ds_read_b64_tr_b16 v[82:83], v63 offset:256
    ds_read_b128 v[68:71], v5
    ds_read_b64_tr_b16 v[84:85], v63 offset:1024
    ds_read_b64_tr_b16 v[86:87], v63 offset:1280
    ds_read_b128 v[72:75], v6
    ds_read_b64_tr_b16 v[88:89], v63 offset:2048
    ds_read_b64_tr_b16 v[90:91], v63 offset:2304
    ds_read_b128 v[76:79], v7
    ds_read_b64_tr_b16 v[92:93], v63 offset:3072
    ds_read_b64_tr_b16 v[94:95], v63 offset:3328
    s_waitcnt lgkmcnt(0)
    s_barrier
    s_cmp_lt_u32 s19, 13
    s_cbranch_scc1 F_NOB2
    v_cvt_pk_bf16_f32 v36, v96, 0
    v_cvt_pk_bf16_f32 v37, v97, 0
    v_cvt_pk_bf16_f32 v38, v98, 0
    v_cvt_pk_bf16_f32 v39, v99, 0
    v_mul_f32 v40, 0xbfb8aa3b, v112
    v_mul_f32 v41, 0xbfb8aa3b, v113
    v_mul_f32 v42, 0xbfb8aa3b, v114
    v_mul_f32 v43, 0xbfb8aa3b, v115
    v_sub_u32 v52, 0x8000, v36
    v_sub_u32 v53, 0x8000, v37
    v_sub_u32 v54, 0x8000, v38
    v_sub_u32 v55, 0x8000, v39
    v_and_b32 v32, 0x7fffffff, v40
    v_and_b32 v33, 0x7fffffff, v41
    v_and_b32 v34, 0x7fffffff, v42
    v_and_b32 v35, 0x7fffffff, v43
    v_add_u32 v52, v52, v32
    v_add_u32 v53, v53, v33
    v_add_u32 v54, v54, v34
    v_add_u32 v55, v55, v35
    v_max_i32 v52, 0, v52
    v_max_i32 v53, 0, v53
    v_max_i32 v54, 0, v54
    v_max_i32 v55, 0, v55
    v_and_or_b32 v52, v52, s83, v36
    v_and_or_b32 v53, v53, s83, v37
    v_and_or_b32 v54, v54, s83, v38
    v_and_or_b32 v55, v55, s83, v39
    v_and_or_b32 v96, v40, s84, v52
    v_and_or_b32 v97, v41, s84, v53
    v_and_or_b32 v98, v42, s84, v54
    v_and_or_b32 v99, v43, s84, v55
    v_cvt_pk_bf16_f32 v36, v100, 0
    v_cvt_pk_bf16_f32 v37, v101, 0
    v_cvt_pk_bf16_f32 v38, v102, 0
    v_cvt_pk_bf16_f32 v39, v103, 0
    v_mul_f32 v40, 0xbfb8aa3b, v116
    v_mul_f32 v41, 0xbfb8aa3b, v117
    v_mul_f32 v42, 0xbfb8aa3b, v118
    v_mul_f32 v43, 0xbfb8aa3b, v119
    v_sub_u32 v52, 0x8000, v36
    v_sub_u32 v53, 0x8000, v37
    v_sub_u32 v54, 0x8000, v38
    v_sub_u32 v55, 0x8000, v39
    v_and_b32 v32, 0x7fffffff, v40
    v_and_b32 v33, 0x7fffffff, v41
    v_and_b32 v34, 0x7fffffff, v42
    v_and_b32 v35, 0x7fffffff, v43
    v_add_u32 v52, v52, v32
    v_add_u32 v53, v53, v33
    v_add_u32 v54, v54, v34
    v_add_u32 v55, v55, v35
    v_max_i32 v52, 0, v52
    v_max_i32 v53, 0, v53
    v_max_i32 v54, 0, v54
    v_max_i32 v55, 0, v55
    v_and_or_b32 v52, v52, s83, v36
    v_and_or_b32 v53, v53, s83, v37
    v_and_or_b32 v54, v54, s83, v38
    v_and_or_b32 v55, v55, s83, v39
    v_and_or_b32 v100, v40, s84, v52
    v_and_or_b32 v101, v41, s84, v53
    v_and_or_b32 v102, v42, s84, v54
    v_and_or_b32 v103, v43, s84, v55
    v_cvt_pk_bf16_f32 v36, v104, 0
    v_cvt_pk_bf16_f32 v37, v105, 0
    v_cvt_pk_bf16_f32 v38, v106, 0
    v_cvt_pk_bf16_f32 v39, v107, 0
    v_mul_f32 v40, 0xbfb8aa3b, v120
    v_mul_f32 v41, 0xbfb8aa3b, v121
    v_mul_f32 v42, 0xbfb8aa3b, v122
    v_mul_f32 v43, 0xbfb8aa3b, v123
    v_sub_u32 v52, 0x8000, v36
    v_sub_u32 v53, 0x8000, v37
    v_sub_u32 v54, 0x8000, v38
    v_sub_u32 v55, 0x8000, v39
    v_and_b32 v32, 0x7fffffff, v40
    v_and_b32 v33, 0x7fffffff, v41
    v_and_b32 v34, 0x7fffffff, v42
    v_and_b32 v35, 0x7fffffff, v43
    v_add_u32 v52, v52, v32
    v_add_u32 v53, v53, v33
    v_add_u32 v54, v54, v34
    v_add_u32 v55, v55, v35
    v_max_i32 v52, 0, v52
    v_max_i32 v53, 0, v53
    v_max_i32 v54, 0, v54
    v_max_i32 v55, 0, v55
    v_and_or_b32 v52, v52, s83, v36
    v_and_or_b32 v53, v53, s83, v37
    v_and_or_b32 v54, v54, s83, v38
    v_and_or_b32 v55, v55, s83, v39
    v_and_or_b32 v104, v40, s84, v52
    v_and_or_b32 v105, v41, s84, v53
    v_and_or_b32 v106, v42, s84, v54
    v_and_or_b32 v107, v43, s84, v55
    v_cvt_pk_bf16_f32 v36, v108, 0
    v_cvt_pk_bf16_f32 v37, v109, 0
    v_cvt_pk_bf16_f32 v38, v110, 0
    v_cvt_pk_bf16_f32 v39, v111, 0
    v_mul_f32 v40, 0xbfb8aa3b, v124
    v_mul_f32 v41, 0xbfb8aa3b, v125
    v_mul_f32 v42, 0xbfb8aa3b, v126
    v_mul_f32 v43, 0xbfb8aa3b, v127
    v_sub_u32 v52, 0x8000, v36
    v_sub_u32 v53, 0x8000, v37
    v_sub_u32 v54, 0x8000, v38
    v_sub_u32 v55, 0x8000, v39
    v_and_b32 v32, 0x7fffffff, v40
    v_and_b32 v33, 0x7fffffff, v41
    v_and_b32 v34, 0x7fffffff, v42
    v_and_b32 v35, 0x7fffffff, v43
    v_add_u32 v52, v52, v32
    v_add_u32 v53, v53, v33
    v_add_u32 v54, v54, v34
    v_add_u32 v55, v55, v35
    v_max_i32 v52, 0, v52
    v_max_i32 v53, 0, v53
    v_max_i32 v54, 0, v54
    v_max_i32 v55, 0, v55
    v_and_or_b32 v52, v52, s83, v36
    v_and_or_b32 v53, v53, s83, v37
    v_and_or_b32 v54, v54, s83, v38
    v_and_or_b32 v55, v55, s83, v39
    v_and_or_b32 v108, v40, s84, v52
    v_and_or_b32 v109, v41, s84, v53
    v_and_or_b32 v110, v42, s84, v54
    v_and_or_b32 v111, v43, s84, v55
    s_waitcnt vmcnt(0)
    buffer_store_dword v96, v49, s[60:63], 0 offen offset:0 sc1
    buffer_store_dword v97, v49, s[60:63], 0 offen offset:128 sc1
    buffer_store_dword v98, v49, s[60:63], 0 offen offset:256 sc1
    buffer_store_dword v99, v49, s[60:63], 0 offen offset:384 sc1
    buffer_store_dword v100, v49, s[60:63], 0 offen offset:1024 sc1
    buffer_store_dword v101, v49, s[60:63], 0 offen offset:1152 sc1
    buffer_store_dword v102, v49, s[60:63], 0 offen offset:1280 sc1
    buffer_store_dword v103, v49, s[60:63], 0 offen offset:1408 sc1
    buffer_store_dword v104, v49, s[60:63], 0 offen offset:2048 sc1
    buffer_store_dword v105, v49, s[60:63], 0 offen offset:2176 sc1
    buffer_store_dword v106, v49, s[60:63], 0 offen offset:2304 sc1
    buffer_store_dword v107, v49, s[60:63], 0 offen offset:2432 sc1
    buffer_store_dword v108, v49, s[60:63], 0 offen offset:3072 sc1
    buffer_store_dword v109, v49, s[60:63], 0 offen offset:3200 sc1
    buffer_store_dword v110, v49, s[60:63], 0 offen offset:3328 sc1
    buffer_store_dword v111, v49, s[60:63], 0 offen offset:3456 sc1
    s_cmp_lg_u32 s19, 13
    s_cbranch_scc1 F_NOMINI
    s_movk_i32 s85, 12288
    s_mov_b32 exec_hi, 0
    v_cvt_pk_bf16_f32 v36, v0, 0
    v_cvt_pk_bf16_f32 v37, v1, 0
    v_mul_f32 v40, 0xbfb8aa3b, v16
    v_mul_f32 v41, 0xbfb8aa3b, v17
    v_sub_u32 v52, 0x8000, v36
    v_sub_u32 v53, 0x8000, v37
    v_and_b32 v32, 0x7fffffff, v40
    v_and_b32 v33, 0x7fffffff, v41
    v_add_u32 v52, v52, v32
    v_add_u32 v53, v53, v33
    v_max_i32 v52, 0, v52
    v_max_i32 v53, 0, v53
    v_and_or_b32 v52, v52, s83, v36
    v_and_or_b32 v53, v53, s83, v37
    v_and_or_b32 v0, v40, s84, v52
    buffer_store_dword v0, v49, s[60:63], s85 offen offset:0 sc1
    v_and_or_b32 v1, v41, s84, v53
    buffer_store_dword v1, v49, s[60:63], s85 offen offset:128 sc1
    s_mov_b32 exec_hi, -1
    s_branch F_SIDE1_DONE
F_NOMINI:
    s_cmp_eq_u32 s19, 14
    s_cbranch_scc1 F_SIDE1_DONE
    v_lshlrev_b32 v1, 16, v1
    v_mul_f32 v1, 0xbfb8aa3b, v1
    v_cvt_pk_bf16_f32 v20, v1, 0
    v_lshlrev_b32 v20, 16, v20
    v_sub_f32 v21, v1, v20
    v_cvt_pk_bf16_f32 v1, v20, v21
    v_lshlrev_b32 v3, 16, v3
    v_mul_f32 v3, 0xbfb8aa3b, v3
    v_cvt_pk_bf16_f32 v20, v3, 0
    v_lshlrev_b32 v20, 16, v20
    v_sub_f32 v21, v3, v20
    v_cvt_pk_bf16_f32 v3, v20, v21
    v_cmp_gt_u32 s[78:79], 32, v60
    s_nop 1
    v_cndmask_b32 v8, 0, v0, s[78:79]
    v_cndmask_b32 v9, 0, v2, s[78:79]
    v_cndmask_b32 v10, 0, v1, s[78:79]
    v_cndmask_b32 v11, 0, v3, s[78:79]
    v_lshlrev_b32 v22, 3, v60
    v_lshlrev_b32 v23, 2, v60
    s_mov_b32 exec_hi, 3
    ds_write_b64 v22, v[8:9] offset:36160
    ds_write_b64 v22, v[10:11] offset:36432
    s_mov_b32 exec_hi, 0
    ds_write_b32 v23, v30 offset:36032
    s_mov_b64 exec, -1
F_SIDE1_DONE:
F_NOB2:
    v_mfma_f32_32x32x16_bf16 v[96:111], v[64:67], v[80:83], 0
    v_mfma_f32_32x32x16_bf16 v[96:111], v[68:71], v[84:87], v[96:111]
    v_mfma_f32_32x32x16_bf16 v[96:111], v[72:75], v[88:91], v[96:111]
    v_mfma_f32_32x32x16_bf16 v[96:111], v[76:79], v[92:95], v[96:111]
    v_mov_b64 v[12:13], 0
    v_mov_b64 v[14:15], 0
    v_mul_u32_u24 v20, 0x80008, v61
    v_add_u32 v20, 0x7f817f80, v20
    v_add_u32 v21, 0x20002, v20
    v_add_u32 v22, 0x40004, v20
    v_add_u32 v23, 0x60006, v20
    v_mfma_f32_32x32x16_bf16 v[112:127], v[12:15], v[12:15], 0
    v_add_u32 v24, 0x20002000, v20
    v_add_u32 v25, 0x20002000, v21
    v_add_u32 v26, 0x20002000, v22
    v_add_u32 v27, 0x20002000, v23
    v_add_u32 v28, 49024, v62
    v_lshlrev_b32 v29, 17, v61
    v_add_u32 v29, 0x3b000000, v29
    v_add_u32 v30, 0x10000, v29
    v_mul_f32 v31, 0x3fb8aa3b, v29
    v_mul_f32 v32, 0x3fb8aa3b, v30
    v_exp_f32 v31, v31
    v_exp_f32 v32, v32
    s_cmp_lg_u32 s19, 0
    s_cbranch_scc1 F_LUT2
    s_mov_b32 s3, 0x80008000
    v_pk_max_u16 v20, v20, s3
    v_pk_max_u16 v21, v21, s3
    v_pk_max_u16 v22, v22, s3
    v_pk_max_u16 v23, v23, s3
F_LUT2:
    ds_write_b128 v28, v[20:23]
    v_add_f32 v31, 1.0, v31
    v_add_f32 v32, 1.0, v32
    v_rcp_f32 v31, v31
    v_rcp_f32 v32, v32
    s_cmp_gt_u32 s19, 13
    s_cbranch_scc1 F_LUT4
    s_cmp_lt_u32 s19, 13
    s_cbranch_scc1 F_LUT3
    s_mov_b32 exec_hi, 0
F_LUT3:
    ds_write_b128 v28, v[24:27] offset:16384
    s_mov_b32 exec_hi, -1
F_LUT4:
    v_mul_f32 v31, v29, v31
    v_mul_f32 v32, v30, v32
    v_lshlrev_b32 v50, 2, v61
    v_cvt_pk_bf16_f32 v31, -v31, -v32
    v_add_u32 v33, 79232, v50
    ds_write_b32 v33, v31
    s_mov_b32 s56, 0xbfb8aa3b
    s_mov_b32 s57, 0xbfb8aa3b
    s_and_b32 s54, s19, 3
    s_cmp_lg_u32 s54, 1
    s_cbranch_scc1 F_NOSC
    v_pk_mul_f32 v[96:97], v[96:97], s[56:57]
    v_pk_mul_f32 v[98:99], v[98:99], s[56:57]
    v_pk_mul_f32 v[100:101], v[100:101], s[56:57]
    v_pk_mul_f32 v[102:103], v[102:103], s[56:57]
    v_pk_mul_f32 v[104:105], v[104:105], s[56:57]
    v_pk_mul_f32 v[106:107], v[106:107], s[56:57]
    v_pk_mul_f32 v[108:109], v[108:109], s[56:57]
    v_pk_mul_f32 v[110:111], v[110:111], s[56:57]
F_NOSC:
    s_lshl_b32 s54, s54, 9
    s_lshr_b32 s55, s19, 2
    s_lshr_b32 s3, s55, 1
    s_lshl_b32 s3, s3, 8
    s_add_u32 s54, s54, s3
    s_and_b32 s3, s55, 1
    s_lshl2_add_u32 s54, s3, s54
    s_add_u32 s54, s54, 130944
    v_and_b32 v41, 31, v60
    v_lshl_add_u32 v41, v41, 3, s54
    v_lshrrev_b32 v40, 5, v60
    v_lshl_add_u32 v40, v40, 13, v41
    v_cvt_pk_bf16_f32 v32, v96, v104
    ds_write_b32 v40, v32 offset:0
    v_cvt_pk_bf16_f32 v33, v97, v105
    ds_write_b32 v40, v33 offset:2048
    v_cvt_pk_bf16_f32 v34, v98, v106
    ds_write_b32 v40, v34 offset:4096
    v_cvt_pk_bf16_f32 v35, v99, v107
    ds_write_b32 v40, v35 offset:6144
    v_cvt_pk_bf16_f32 v36, v100, v108
    ds_write_b32 v40, v36 offset:16384
    v_cvt_pk_bf16_f32 v37, v101, v109
    ds_write_b32 v40, v37 offset:18432
    v_cvt_pk_bf16_f32 v38, v102, v110
    ds_write_b32 v40, v38 offset:20480
    v_cvt_pk_bf16_f32 v39, v103, v111
    ds_write_b32 v40, v39 offset:22528
    v_mfma_f32_32x32x16_bf16 v[96:111], v[12:15], v[12:15], 0
    s_and_b32 s74, s19, 3
    s_bitcmp1_b32 s19, 2
    s_cselect_b32 s3, 3, 0
    s_xor_b32 s74, s74, s3
    s_lshl2_add_u32 s74, s55, s74
    v_lshrrev_b32 v0, 5, v60
    v_lshlrev_b32 v0, 4, v0
    s_mov_b32 s44, s16
    s_and_b32 s45, s17, 0xffff
    s_or_b32 s45, s45, 0x80000000
    s_mov_b32 s46, 0x100000
    s_mov_b32 s47, 0xc00000
    s_add_u32 s48, s16, 13631488
    s_addc_u32 s49, s17, 0
    s_and_b32 s49, s49, 0xffff
    s_or_b32 s49, s49, 262144
    s_mov_b32 s50, 400000
    s_mov_b32 s51, 0x20000
    s_mov_b32 s22, 0
    s_mov_b32 s82, 0
    s_mul_i32 s3, s18, 32896
    s_lshl_b32 s54, s19, 11
    s_add_u32 s3, s3, s54
    s_add_u32 s3, s3, 4194304
    v_lshl_add_u32 v52, v60, 4, s3
    s_mul_i32 s3, s19, 401408
    s_add_u32 s3, s3, 15728640
    v_and_b32 v53, 7, v60
    v_lshl_add_u32 v53, v53, 4, s3
    v_lshrrev_b32 v54, 3, v60
    s_movk_i32 s3, 25088
    v_mad_u32_u24 v53, v54, s3, v53
    v_lshlrev_b32 v50, 2, v60
    v_and_b32 v51, 63, v50
    v_and_b32 v49, 48, v60
    v_mov_b32 v48, 4
    s_lshl_b32 s3, s19, 11
    s_add_u32 s3, s3, 14680064
    v_lshl_add_u32 v46, v51, 5, s3
    s_mov_b32 s83, 0x20000
    s_or_b32 s84, s72, 0x1abcd
    s_waitcnt vmcnt(0)
    s_cmp_lt_u32 s19, 13
    s_cbranch_scc1 F_POLL0
    s_mov_b64 exec, 1
    ds_add_rtn_u32 v44, v12, v48 offset:35908
    s_mov_b64 exec, 1
    s_lshl_b32 s3, s18, 7
    s_add_u32 s3, s3, 14680064
    v_lshl_add_u32 v45, v60, 15, s3
    v_mov_b32 v43, s84
    s_waitcnt lgkmcnt(0)
    v_readfirstlane_b32 s3, v44
    s_nop 0
    s_cmp_lg_u32 s3, 8
    s_cbranch_scc1 F_NOFLAG
    global_store_dword v45, v43, s[16:17] sc1
F_NOFLAG:
    s_setprio 0
    s_mov_b64 exec, -1
F_POLL0:
    global_load_dwordx4 v[80:83], v52, s[16:17] sc1
    global_load_dwordx4 v[84:87], v52, s[16:17] offset:1024 sc1
    s_add_u32 s82, s82, 1
    s_cmp_gt_u32 s82, 262144
    s_cbranch_scc1 K2_END
F_POLL1:
    s_waitcnt vmcnt(0)
    v_xor_b32 v80, s72, v80
    v_xor_b32 v82, s72, v82
    v_xor_b32 v84, s72, v84
    v_xor_b32 v86, s72, v86
    v_or3_b32 v44, v80, v82, v84
    v_or_b32 v44, v44, v86
    v_cmp_gt_u32 vcc, s83, v44
    s_nop 0
    s_cmp_eq_u64 vcc, -1
    s_cbranch_scc1 F_L0_OK
F_REPOLL:
    v_or_b32 v44, v80, v82
    v_cmp_le_u32 s[78:79], s83, v44
    s_nop 0
    s_lshr_b64 s[56:57], s[78:79], 4
    s_or_b64 s[78:79], s[78:79], s[56:57]
    s_lshr_b64 s[56:57], s[78:79], 2
    s_or_b64 s[78:79], s[78:79], s[56:57]
    s_lshr_b64 s[56:57], s[78:79], 1
    s_or_b64 s[78:79], s[78:79], s[56:57]
    s_and_b32 s78, s78, 0x01010101
    s_mul_i32 s78, s78, 255
    s_and_b32 s79, s79, 0x01010101
    s_mul_i32 s79, s79, 255
    v_or_b32 v44, v84, v86
    v_cmp_le_u32 s[80:81], s83, v44
    s_nop 0
    s_lshr_b64 s[56:57], s[80:81], 4
    s_or_b64 s[80:81], s[80:81], s[56:57]
    s_lshr_b64 s[56:57], s[80:81], 2
    s_or_b64 s[80:81], s[80:81], s[56:57]
    s_lshr_b64 s[56:57], s[80:81], 1
    s_or_b64 s[80:81], s[80:81], s[56:57]
    s_and_b32 s80, s80, 0x01010101
    s_mul_i32 s80, s80, 255
    s_and_b32 s81, s81, 0x01010101
    s_mul_i32 s81, s81, 255
    s_or_b64 s[56:57], s[78:79], s[80:81]
    s_cbranch_scc0 F_L0_OK
    s_mov_b64 exec, s[78:79]
    global_load_dwordx4 v[80:83], v52, s[16:17] sc1
    s_mov_b64 exec, s[80:81]
    global_load_dwordx4 v[84:87], v52, s[16:17] offset:1024 sc1
    s_add_u32 s82, s82, 1
    s_cmp_gt_u32 s82, 262144
    s_cbranch_scc1 K2_END
    s_waitcnt vmcnt(0)
    v_xor_b32 v84, s72, v84
    v_xor_b32 v86, s72, v86
    s_mov_b64 exec, s[78:79]
    v_xor_b32 v80, s72, v80
    v_xor_b32 v82, s72, v82
    s_mov_b64 exec, -1
    s_branch F_REPOLL
F_L0_OK:
    v_bfe_u32 v54, v81, 1, 8
    v_bfe_u32 v55, v85, 1, 8
    v_bfe_u32 v56, v83, 1, 8
    v_bfe_u32 v57, v87, 1, 8
    v_cmp_lt_u32 s[78:79], 0, v54
    v_cmp_lt_u32 s[80:81], 0, v55
    v_lshl_add_u32 v56, v56, 7, v53
    v_lshl_add_u32 v57, v57, 7, v53
    v_add_u32 v57, 200704, v57
    v_cmp_ne_u32 s[24:25], 0, v81
    v_cmp_ne_u32 s[26:27], 0, v83
    v_cmp_ne_u32 s[28:29], 0, v85
    v_cmp_ne_u32 s[30:31], 0, v87
    s_mov_b64 exec, s[78:79]
    global_load_dwordx4 v[88:91], v56, s[16:17] sc1
    s_mov_b64 exec, s[80:81]
    global_load_dwordx4 v[92:95], v57, s[16:17] sc1
    s_mov_b64 exec, s[24:25]
    v_lshrrev_b32 v64, 10, v81
    v_and_b32 v64, 0x3c, v64
    ds_add_rtn_u32 v64, v64, v48 offset:35584
    s_mov_b64 exec, s[26:27]
    v_lshrrev_b32 v65, 10, v83
    v_and_b32 v65, 0x3c, v65
    ds_add_rtn_u32 v65, v65, v48 offset:35584
    s_mov_b64 exec, s[28:29]
    v_lshrrev_b32 v66, 10, v85
    v_and_b32 v66, 0x3c, v66
    ds_add_rtn_u32 v66, v66, v48 offset:35584
    s_mov_b64 exec, s[30:31]
    v_lshrrev_b32 v67, 10, v87
    v_and_b32 v67, 0x3c, v67
    ds_add_rtn_u32 v67, v67, v48 offset:35584
    s_mov_b64 exec, s[24:25]
    s_waitcnt lgkmcnt(3)
    v_min_u32 v64, 17788, v64
    ds_write_b32 v64, v80 offset:0
    ds_write_b32 v64, v81 offset:17792
    s_mov_b64 exec, s[26:27]
    s_waitcnt lgkmcnt(4)
    v_min_u32 v65, 17788, v65
    ds_write_b32 v65, v82 offset:0
    ds_write_b32 v65, v83 offset:17792
    s_mov_b64 exec, s[28:29]
    s_waitcnt lgkmcnt(5)
    v_min_u32 v66, 17788, v66
    ds_write_b32 v66, v84 offset:0
    ds_write_b32 v66, v85 offset:17792
    s_mov_b64 exec, s[30:31]
    s_waitcnt lgkmcnt(6)
    v_min_u32 v67, 17788, v67
    ds_write_b32 v67, v86 offset:0
    ds_write_b32 v67, v87 offset:17792
    s_mov_b64 exec, -1
    s_waitcnt lgkmcnt(0)
    s_barrier
    global_load_dword v76, v46, s[16:17] sc1
    s_cmp_lg_u32 s19, 0
    s_cbranch_scc1 F_NORANK
    ds_read_b32 v33, v51 offset:35584
    ds_read_b32 v35, v51 offset:35712
    ds_read_b128 v[36:39], v49 offset:35584
    ds_read_b128 v[40:43], v49 offset:35712
    v_lshrrev_b32 v34, 2, v51
    s_waitcnt lgkmcnt(0)
    v_lshl_add_u32 v35, v33, 2, v35
    v_lshl_add_u32 v36, v36, 2, v40
    v_lshl_add_u32 v37, v37, 2, v41
    v_lshl_add_u32 v38, v38, 2, v42
    v_lshl_add_u32 v39, v39, 2, v43
    v_cmp_gt_u32 s[24:25], v36, v35
    v_cmp_gt_u32 s[26:27], v37, v35
    v_cmp_gt_u32 s[28:29], v38, v35
    v_cmp_gt_u32 s[30:31], v39, v35
    v_cndmask_b32 v36, 0, 1, s[24:25]
    v_addc_co_u32 v36, s[56:57], 0, v36, s[26:27]
    v_addc_co_u32 v36, s[56:57], 0, v36, s[28:29]
    v_addc_co_u32 v36, s[56:57], 0, v36, s[30:31]
    v_mov_b32 v37, v36
    s_nop 1
    v_permlane32_swap_b32 v37, v36
    v_add_u32 v36, v36, v37
    v_mov_b32 v37, v36
    s_nop 1
    v_permlane16_swap_b32 v37, v36
    v_add_lshl_u32 v36, v36, v37, 2
    v_mov_b32 v34, v35
    ds_write_b32 v36, v34 offset:35968
F_NORANK:
    s_mov_b32 s21, 1
    s_lshl_b32 s3, s74, 2
    v_mov_b32 v32, s3
    s_waitcnt vmcnt(1)
F_L1_CHECK:
    v_xor_b32 v88, s72, v88
    v_xor_b32 v90, s72, v90
    v_xor_b32 v92, s72, v92
    v_xor_b32 v94, s72, v94
    v_or_b32 v44, v88, v90
    v_or_b32 v45, v92, v94
    v_cmp_le_u32 vcc, s83, v44
    v_cmp_le_u32 s[56:57], s83, v45
    s_and_b64 vcc, vcc, s[78:79]
    s_and_b64 s[56:57], s[56:57], s[80:81]
    s_or_b64 vcc, vcc, s[56:57]
    s_cbranch_scc1 F_L1_RETRY
    v_cmp_ne_u32 s[24:25], 0, v89
    v_cmp_ne_u32 s[26:27], 0, v91
    v_cmp_ne_u32 s[28:29], 0, v93
    v_cmp_ne_u32 s[30:31], 0, v95
    s_and_b64 s[24:25], s[24:25], s[78:79]
    s_and_b64 s[26:27], s[26:27], s[78:79]
    s_and_b64 s[28:29], s[28:29], s[80:81]
    s_and_b64 s[30:31], s[30:31], s[80:81]
    s_waitcnt lgkmcnt(0)
    s_barrier
    ds_read_b32 v32, v32 offset:35968
    s_or_b64 s[56:57], s[78:79], s[80:81]
    s_cbranch_scc0 F_LEVEL_DONE
F_LEVEL:
    s_mov_b64 exec, s[24:25]
    v_lshrrev_b32 v36, 10, v89
    v_and_b32 v36, 0x3c, v36
    ds_add_rtn_u32 v36, v36, v48 offset:35584
    s_mov_b64 exec, s[26:27]
    v_lshrrev_b32 v37, 10, v91
    v_and_b32 v37, 0x3c, v37
    ds_add_rtn_u32 v37, v37, v48 offset:35584
    s_mov_b64 exec, s[28:29]
    v_lshrrev_b32 v38, 10, v93
    v_and_b32 v38, 0x3c, v38
    ds_add_rtn_u32 v38, v38, v48 offset:35584
    s_mov_b64 exec, s[30:31]
    v_lshrrev_b32 v39, 10, v95
    v_and_b32 v39, 0x3c, v39
    ds_add_rtn_u32 v39, v39, v48 offset:35584
    s_mov_b64 exec, s[24:25]
    s_waitcnt lgkmcnt(3)
    v_min_u32 v36, 17788, v36
    ds_write_b32 v36, v88 offset:0
    ds_write_b32 v36, v89 offset:17792
    s_mov_b64 exec, s[26:27]
    s_waitcnt lgkmcnt(4)
    v_min_u32 v37, 17788, v37
    ds_write_b32 v37, v90 offset:0
    ds_write_b32 v37, v91 offset:17792
    s_mov_b64 exec, s[28:29]
    s_waitcnt lgkmcnt(5)
    v_min_u32 v38, 17788, v38
    ds_write_b32 v38, v92 offset:0
    ds_write_b32 v38, v93 offset:17792
    s_mov_b64 exec, s[30:31]
    s_waitcnt lgkmcnt(6)
    v_min_u32 v39, 17788, v39
    ds_write_b32 v39, v94 offset:0
    ds_write_b32 v39, v95 offset:17792
    s_mov_b64 exec, -1
    v_cmp_lt_u32 s[78:79], s21, v54
    v_cmp_lt_u32 s[80:81], s21, v55
    s_add_u32 s21, s21, 1
    s_or_b64 s[56:57], s[78:79], s[80:81]
    s_cbranch_scc0 F_LEVEL_DONE
    v_add_u32 v56, 128, v56
    v_add_u32 v57, 128, v57
F_LEVEL_LOAD:
    s_mov_b64 exec, s[78:79]
    global_load_dwordx4 v[88:91], v56, s[16:17] sc1
    s_mov_b64 exec, s[80:81]
    global_load_dwordx4 v[92:95], v57, s[16:17] sc1
    s_mov_b64 exec, -1
    s_add_u32 s82, s82, 1
    s_cmp_gt_u32 s82, 262144
    s_cbranch_scc1 K2_END
    s_waitcnt vmcnt(0)
    v_xor_b32 v88, s72, v88
    v_xor_b32 v90, s72, v90
    v_xor_b32 v92, s72, v92
    v_xor_b32 v94, s72, v94
    v_or_b32 v44, v88, v90
    v_or_b32 v45, v92, v94
    v_cmp_le_u32 vcc, s83, v44
    v_cmp_le_u32 s[56:57], s83, v45
    s_and_b64 vcc, vcc, s[78:79]
    s_and_b64 s[56:57], s[56:57], s[80:81]
    s_or_b64 vcc, vcc, s[56:57]
    s_cbranch_scc1 F_LEVEL_LOAD
    v_cmp_ne_u32 s[24:25], 0, v89
    v_cmp_ne_u32 s[26:27], 0, v91
    v_cmp_ne_u32 s[28:29], 0, v93
    v_cmp_ne_u32 s[30:31], 0, v95
    s_and_b64 s[24:25], s[24:25], s[78:79]
    s_and_b64 s[26:27], s[26:27], s[78:79]
    s_and_b64 s[28:29], s[28:29], s[80:81]
    s_and_b64 s[30:31], s[30:31], s[80:81]
    s_branch F_LEVEL
F_L1_RETRY:
    s_mov_b64 exec, s[78:79]
    global_load_dwordx4 v[88:91], v56, s[16:17] sc1
    s_mov_b64 exec, s[80:81]
    global_load_dwordx4 v[92:95], v57, s[16:17] sc1
    s_mov_b64 exec, -1
    s_add_u32 s82, s82, 1
    s_cmp_gt_u32 s82, 262144
    s_cbranch_scc1 K2_END
    s_waitcnt vmcnt(0)
    s_branch F_L1_CHECK
F_LEVEL_DONE:
    s_waitcnt lgkmcnt(0)
    v_readfirstlane_b32 s73, v32
    s_nop 0
    s_lshr_b32 s75, s73, 10
    s_and_b32 s73, s73, 15
    s_mul_i32 s53, s73, 1088
    s_mul_i32 s3, s73, 192
    s_add_u32 s3, s3, 17408
    s_cmp_lt_u32 s73, 2
    s_cselect_b32 s3, s3, 0
    s_add_u32 s53, s53, s3
    s_sub_u32 s53, s53, 2176
    v_add_u32 v0, s53, v0
    s_mov_b32 m0, s53
    s_cmp_eq_u32 s75, 0
    s_cbranch_scc1 F_FLAGS
    s_cmp_ge_u32 s19, 8
    s_cbranch_scc1 F_FLAGS
    ds_read_addtid_b32 v4 offset:0
    ds_read_addtid_b32 v7 offset:17792
    s_waitcnt lgkmcnt(0)
    buffer_load_dwordx3 v[4:6], v4, s[48:51], 0 idxen sc1
    s_add_u32 m0, m0, 256
    s_waitcnt vmcnt(1)
    s_branch F_FLAGS1
F_FLAGS:
    s_waitcnt vmcnt(0)
F_FLAGS1:
    v_cmp_ne_u32 vcc, s84, v76
    s_cbranch_vccz F_READY
    global_load_dword v76, v46, s[16:17] sc1
    s_add_u32 s82, s82, 1
    s_cmp_gt_u32 s82, 262144
    s_cbranch_scc1 K2_END
    s_branch F_FLAGS
F_READY:
    s_or_b32 s3, s18, s19
    s_cbranch_scc1 F_NOEPOCH
    v_mov_b32 v44, 14942208
    v_mov_b32 v45, s72
    s_mov_b64 exec, 1
    global_store_dword v44, v45, s[16:17] sc1
    s_mov_b64 exec, -1
F_NOEPOCH:
    s_barrier
    ds_read_b32 v33, v51 offset:35584
    ds_read_b32 v34, v51 offset:35776
    ds_read_b128 v[64:67], v0 offset:0
    ds_read_b128 v[68:71], v0 offset:32
    ds_read_b128 v[72:75], v0 offset:64
    ds_read_b128 v[76:79], v0 offset:96
    s_waitcnt lgkmcnt(4)
    v_cmp_gt_u32 vcc, v33, v34
    v_readlane_b32 s20, v33, s73
    s_cbranch_vccnz F_SOFT
F_FAST:
    s_sub_u32 s3, s20, s53
    s_cmp_eq_u32 s75, 0
    s_cbranch_scc1 F_OTHER
    s_cmp_lt_u32 s3, 256
    s_cbranch_scc1 F_OTHER
    s_waitcnt lgkmcnt(3)
    buffer_load_dword v64, v64, s[44:47], 0 offen sc1
    buffer_load_dword v65, v65, s[44:47], 0 offen sc1
    buffer_load_dword v66, v66, s[44:47], 0 offen sc1
    buffer_load_dword v67, v67, s[44:47], 0 offen sc1
    s_waitcnt lgkmcnt(2)
    buffer_load_dword v68, v68, s[44:47], 0 offen sc1
    buffer_load_dword v69, v69, s[44:47], 0 offen sc1
    buffer_load_dword v70, v70, s[44:47], 0 offen sc1
    buffer_load_dword v71, v71, s[44:47], 0 offen sc1
    s_waitcnt lgkmcnt(1)
    buffer_load_dword v72, v72, s[44:47], 0 offen sc1
    buffer_load_dword v73, v73, s[44:47], 0 offen sc1
    buffer_load_dword v74, v74, s[44:47], 0 offen sc1
    buffer_load_dword v75, v75, s[44:47], 0 offen sc1
    s_waitcnt lgkmcnt(0)
    buffer_load_dword v76, v76, s[44:47], 0 offen sc1
    buffer_load_dword v77, v77, s[44:47], 0 offen sc1
    buffer_load_dword v78, v78, s[44:47], 0 offen sc1
    buffer_load_dword v79, v79, s[44:47], 0 offen sc1
    s_cmp_lt_u32 s19, 8
    s_cbranch_scc1 F_POSDONE
    ds_read_addtid_b32 v4 offset:0
    ds_read_addtid_b32 v7 offset:17792
    s_waitcnt lgkmcnt(0)
    buffer_load_dwordx3 v[4:6], v4, s[48:51], 0 idxen sc1
    s_add_u32 m0, m0, 256
F_POSDONE:
    s_lshr_b32 s20, s3, 2
    s_lshl_b32 s3, s73, 11
    s_add_u32 s3, s3, 130944
    v_lshl_add_u32 v63, v60, 3, s3
    ds_read_b64 v[18:19], v63
    ds_read_b64 v[24:25], v63 offset:512
    ds_read_b64 v[28:29], v63 offset:1024
    ds_read_b64 v[30:31], v63 offset:1536
    v_lshl_add_u32 v3, v60, 4, s3
    ds_write_b128 v3, v[12:15]
    ds_write_b128 v3, v[12:15] offset:1024
    v_and_b32 v35, 31, v60
    v_bfe_u32 v34, v60, 1, 2
    v_lshl_add_u32 v1, v35, 6, s3
    v_lshl_add_u32 v1, v34, 3, v1
    v_lshrrev_b32 v36, 5, v60
    v_bfe_u32 v34, v60, 2, 2
    v_lshl_add_u32 v34, v36, 2, v34
    v_lshl_add_u32 v2, v34, 6, s3
    v_lshrrev_b32 v34, 1, v34
    v_xor_b32 v34, v34, v60
    v_and_b32 v34, 3, v34
    v_lshl_add_u32 v2, v34, 3, v2
    v_and_b32 v34, 16, v60
    v_lshl_add_u32 v2, v34, 1, v2
    v_lshlrev_b32 v35, 3, v35
    v_mov_b32 v34, 256
    v_cmp_gt_u32 vcc, 32, v60
    s_nop 1
    v_cndmask_b32 v8, v34, v35, vcc
    v_cndmask_b32_e64 v9, v35, v34, vcc
    ds_read_b64 v[16:17], v9 offset:36160
    ds_read_b64 v[20:21], v8 offset:36160
    ds_read_b64 v[22:23], v9 offset:36432
    ds_read_b64 v[26:27], v8 offset:36432
    s_add_u32 s23, s23, s73
    s_mov_b32 s52, 0x03020302
    s_mov_b64 s[40:41], 0
    s_mov_b64 s[42:43], 0
    s_and_b32 s54, s20, 63
    s_cbranch_scc0 K2_NOFILLA
    s_bfm_b64 s[56:57], s54, 0
    s_andn2_b32 s54, s20, 63
    s_lshl2_add_u32 m0, s54, s53
    s_not_b64 exec, s[56:57]
    s_cmp_gt_u32 s20, 256
    s_cselect_b32 s54, s73, 0
    s_cmp_lt_u32 s54, 2
    s_cbranch_scc1 K2_FILLA
    s_and_b64 exec, exec, 0xffff
K2_FILLA:
    ds_write_addtid_b32 v12 offset:0
    ds_write_addtid_b32 v12 offset:17792
    s_mov_b64 exec, -1
K2_NOFILLA:
    s_add_u32 m0, s53, 256
    s_branch K2_ISSUED
F_SOFT:
    ds_read_b32 v35, v51 offset:35840
    s_mov_b64 s[78:79], vcc
    v_cmp_lt_u32 vcc, 7, v51
    s_nop 1
    v_cndmask_b32 v36, 0, 64, vcc
    v_add_u32 v34, v34, v36
    s_waitcnt lgkmcnt(0)
    v_sub_u32 v35, v33, v35
    s_nop 1
    v_mov_b32_dpp v36, v35 row_ror:15 row_mask:0xf bank_mask:0xf
    v_cmp_gt_u32 vcc, 192, v36
    s_nop 0
    s_and_b64 s[78:79], s[78:79], vcc
    v_cmp_gt_u32 vcc, v33, v34
    s_nop 0
    s_or_b64 vcc, vcc, s[78:79]
    s_cbranch_scc0 F_FAST
F_OTHER:
    s_waitcnt vmcnt(0)
    s_mov_b64 s[78:79], vcc
    s_lshl_b32 s3, s73, 11
    s_add_u32 s3, s3, 130944
    v_lshl_add_u32 v63, v60, 3, s3
    ds_read_b64 v[18:19], v63
    ds_read_b64 v[24:25], v63 offset:512
    ds_read_b64 v[28:29], v63 offset:1024
    ds_read_b64 v[30:31], v63 offset:1536
    v_lshl_add_u32 v3, v60, 4, s3
    ds_write_b128 v3, v[12:15]
    ds_write_b128 v3, v[12:15] offset:1024
    v_and_b32 v35, 31, v60
    v_bfe_u32 v34, v60, 1, 2
    v_lshl_add_u32 v1, v35, 6, s3
    v_lshl_add_u32 v1, v34, 3, v1
    v_lshrrev_b32 v36, 5, v60
    v_bfe_u32 v34, v60, 2, 2
    v_lshl_add_u32 v34, v36, 2, v34
    v_lshl_add_u32 v2, v34, 6, s3
    v_lshrrev_b32 v34, 1, v34
    v_xor_b32 v34, v34, v60
    v_and_b32 v34, 3, v34
    v_lshl_add_u32 v2, v34, 3, v2
    v_and_b32 v34, 16, v60
    v_lshl_add_u32 v2, v34, 1, v2
    v_lshlrev_b32 v35, 3, v35
    v_mov_b32 v34, 256
    v_cmp_gt_u32 vcc, 32, v60
    s_nop 1
    v_cndmask_b32 v8, v34, v35, vcc
    v_cndmask_b32_e64 v9, v35, v34, vcc
    ds_read_b64 v[16:17], v9 offset:36160
    ds_read_b64 v[20:21], v8 offset:36160
    ds_read_b64 v[22:23], v9 offset:36432
    ds_read_b64 v[26:27], v8 offset:36432
    s_add_u32 s23, s23, s73
    s_mov_b32 s52, 0x03020302
    s_mov_b64 s[40:41], 0
    s_mov_b64 s[42:43], 0
    s_cmp_lg_u64 s[78:79], 0
    s_cbranch_scc1 K2_SLOW
K2_START:
    s_waitcnt lgkmcnt(0)
    s_sub_u32 s20, s20, s53
    s_lshr_b32 s20, s20, 2
    s_cbranch_scc0 K2_LOOP_DONE
    s_and_b32 s54, s20, 63
    s_cbranch_scc0 K2_NOFILLB
    s_bfm_b64 s[56:57], s54, 0
    s_andn2_b32 s54, s20, 63
    s_lshl2_add_u32 m0, s54, s53
    s_not_b64 exec, s[56:57]
    s_cmp_gt_u32 s20, 256
    s_cselect_b32 s54, s73, 0
    s_cmp_lt_u32 s54, 2
    s_cbranch_scc1 K2_FILLB
    s_and_b64 exec, exec, 0xffff
K2_FILLB:
    ds_write_addtid_b32 v12 offset:0
    ds_write_addtid_b32 v12 offset:17792
    s_mov_b64 exec, -1
K2_NOFILLB:
    s_mov_b32 m0, s53
    ds_read_b128 v[64:67], v0 offset:0
    ds_read_b128 v[68:71], v0 offset:32
    ds_read_b128 v[72:75], v0 offset:64
    ds_read_b128 v[76:79], v0 offset:96
    ds_read_addtid_b32 v4 offset:0
    ds_read_addtid_b32 v7 offset:17792
    s_waitcnt lgkmcnt(5)
    buffer_load_dword v64, v64, s[44:47], 0 offen sc1
    buffer_load_dword v65, v65, s[44:47], 0 offen sc1
    buffer_load_dword v66, v66, s[44:47], 0 offen sc1
    buffer_load_dword v67, v67, s[44:47], 0 offen sc1
    s_waitcnt lgkmcnt(4)
    buffer_load_dword v68, v68, s[44:47], 0 offen sc1
    buffer_load_dword v69, v69, s[44:47], 0 offen sc1
    buffer_load_dword v70, v70, s[44:47], 0 offen sc1
    buffer_load_dword v71, v71, s[44:47], 0 offen sc1
    s_waitcnt lgkmcnt(3)
    buffer_load_dword v72, v72, s[44:47], 0 offen sc1
    buffer_load_dword v73, v73, s[44:47], 0 offen sc1
    buffer_load_dword v74, v74, s[44:47], 0 offen sc1
    buffer_load_dword v75, v75, s[44:47], 0 offen sc1
    s_waitcnt lgkmcnt(2)
    buffer_load_dword v76, v76, s[44:47], 0 offen sc1
    buffer_load_dword v77, v77, s[44:47], 0 offen sc1
    buffer_load_dword v78, v78, s[44:47], 0 offen sc1
    buffer_load_dword v79, v79, s[44:47], 0 offen sc1
    s_waitcnt lgkmcnt(0)
    buffer_load_dwordx3 v[4:6], v4, s[48:51], 0 idxen sc1
    s_add_u32 m0, m0, 256
K2_ISSUED:
    s_bfm_b64 s[56:57], s20, 0
    s_cmp_ge_u32 s20, 64
    s_cselect_b32 s40, -1, s56
    s_cselect_b32 s43, -1, s57
    s_waitcnt vmcnt(0)
    v_lshrrev_b32 v32, 4, v7
    v_and_b32 v32, 0xfe0, v32
    ds_read_b128 v[36:39], v32 offset:44944
    ds_read_b64 v[10:11], v32 offset:44928
    ds_read_b64 v[14:15], v32 offset:44936
    s_waitcnt lgkmcnt(2)
    v_perm_b32 v13, v7, v7, s52
    v_sub_f32 v36, v36, v4
    v_sub_f32 v37, v37, v5
    v_sub_f32 v38, v38, v6
    v_xor_b32 v3, v39, v1
    v_cvt_pk_bf16_f32 v8, v36, v37
    v_cvt_pk_bf16_f32 v9, v38, 1.0
    v_lshlrev_b32 v36, 16, v8
    v_and_b32 v37, 0xffff0000, v8
    v_lshlrev_b32 v38, 16, v9
    v_mul_f32 v36, v36, v36
    v_mul_f32 v37, v37, v37
    v_mul_f32 v38, v38, v38
    v_cvt_pk_bf16_f32 v39, v36, v37
    v_cvt_pk_bf16_f32 v38, 0, v38
    v_lshlrev_b32 v36, 16, v39
    v_and_b32 v37, 0xffff0000, v39
    v_add_f32 v36, v36, v37
    v_add_f32 v36, v36, v38
    v_cvt_pk_bf16_f32 v12, v36, v36
    s_waitcnt lgkmcnt(0)
    v_permlane32_swap_b32 v10, v14
    v_permlane32_swap_b32 v11, v15
K2_T0:
    s_setprio 3
    s_cmp_gt_u32 s20, 160
    s_cbranch_scc1 K2_PP0
    s_setprio 2
    s_cmp_gt_u32 s20, 96
    s_cbranch_scc1 K2_PP0
    s_setprio 1
    s_cmp_gt_u32 s20, 32
    s_cbranch_scc1 K2_PP0
    s_setprio 0
K2_PP0:
    s_cmp_le_u32 s20, 32
    s_cbranch_scc1 K2_T0_NG1
    ds_read_b128 v[80:83], v0 offset:128
    ds_read_b128 v[84:87], v0 offset:160
    ds_read_b128 v[88:91], v0 offset:192
    ds_read_b128 v[92:95], v0 offset:224
K2_T0_NG1:
    s_mov_b64 exec, s[40:41]
    ds_write_b64 v3, v[8:9]
    s_mov_b64 exec, -1
    ds_read_b64_tr_b16 v[40:41], v2 offset:0
    ds_read_b64_tr_b16 v[42:43], v2 offset:512
    ds_read_b64_tr_b16 v[44:45], v2 offset:1024
    ds_read_b64_tr_b16 v[46:47], v2 offset:1536
    s_mov_b64 exec, s[40:41]
    ds_write_b64 v3, v[16:17]
    s_mov_b64 exec, -1
    ds_read_addtid_b32 v4 offset:0
    ds_read_addtid_b32 v7 offset:17792
    s_waitcnt vmcnt(0)
    v_lshlrev_b32 v48, 16, v64
    v_lshlrev_b32 v49, 16, v65
    v_lshlrev_b32 v50, 16, v66
    v_lshlrev_b32 v51, 16, v67
    v_lshlrev_b32 v52, 16, v68
    v_lshlrev_b32 v53, 16, v69
    v_lshlrev_b32 v54, 16, v70
    v_lshlrev_b32 v55, 16, v71
    v_lshlrev_b32 v56, 16, v72
    v_lshlrev_b32 v57, 16, v73
    v_lshlrev_b32 v58, 16, v74
    v_lshlrev_b32 v59, 16, v75
    v_lshlrev_b32 v60, 16, v76
    v_lshlrev_b32 v61, 16, v77
    v_lshlrev_b32 v62, 16, v78
    v_lshlrev_b32 v63, 16, v79
    s_nop 1
    v_mfma_f32_32x32x16_bf16 v[48:63], v[10:13], v[18:21], v[48:63]
    v_mfma_f32_32x32x16_bf16 v[64:79], v[10:13], v[24:27], v[64:79]
    s_cmp_le_u32 s20, 32
    s_cbranch_scc1 K2_T0_NG2
K2_T0_NG2:
    s_nop 9
K2_T0_GO:
    v_cvt_pk_bf16_f32 v48, v48, v49
    v_cvt_pk_bf16_f32 v49, v50, v51
    v_cvt_pk_bf16_f32 v50, v52, v53
    v_cvt_pk_bf16_f32 v51, v54, v55
    v_lshlrev_b16 v52, 1, v48
    v_lshlrev_b16_sdwa v32, 1, v48 dst_sel:DWORD dst_unused:UNUSED_PAD src0_sel:DWORD src1_sel:WORD_1
    ds_read_u16 v52, v52 offset:49024
    ds_read_u16_d16_hi v32, v32 offset:49024
    v_lshlrev_b16 v53, 1, v49
    v_lshlrev_b16_sdwa v33, 1, v49 dst_sel:DWORD dst_unused:UNUSED_PAD src0_sel:DWORD src1_sel:WORD_1
    ds_read_u16 v53, v53 offset:49024
    ds_read_u16_d16_hi v33, v33 offset:49024
    v_lshlrev_b16 v54, 1, v50
    v_lshlrev_b16_sdwa v34, 1, v50 dst_sel:DWORD dst_unused:UNUSED_PAD src0_sel:DWORD src1_sel:WORD_1
    ds_read_u16 v54, v54 offset:49024
    ds_read_u16_d16_hi v34, v34 offset:49024
    v_lshlrev_b16 v55, 1, v51
    v_lshlrev_b16_sdwa v35, 1, v51 dst_sel:DWORD dst_unused:UNUSED_PAD src0_sel:DWORD src1_sel:WORD_1
    ds_read_u16 v55, v55 offset:49024
    ds_read_u16_d16_hi v35, v35 offset:49024
    v_pk_max_i16 v48, v48, 0
    v_pk_max_i16 v49, v49, 0
    v_pk_max_i16 v50, v50, 0
    v_pk_max_i16 v51, v51, 0
    v_exp_f32 v36, v64
    v_exp_f32 v37, v65
    v_exp_f32 v38, v66
    v_exp_f32 v39, v67
    v_add_f32 v36, 1.0, v36
    v_add_f32 v37, 1.0, v37
    v_add_f32 v38, 1.0, v38
    v_add_f32 v39, 1.0, v39
    v_rcp_f32 v36, v36
    v_rcp_f32 v37, v37
    v_rcp_f32 v38, v38
    v_rcp_f32 v39, v39
    v_mul_f32 v36, v64, v36
    v_mul_f32 v37, v65, v37
    v_mul_f32 v38, v66, v38
    v_mul_f32 v39, v67, v39
    v_cvt_pk_bf16_f32 v64, v36, v37
    v_cvt_pk_bf16_f32 v65, v38, v39
    v_exp_f32 v36, v68
    v_exp_f32 v37, v69
    v_exp_f32 v38, v70
    v_exp_f32 v39, v71
    v_add_f32 v36, 1.0, v36
    v_add_f32 v37, 1.0, v37
    v_add_f32 v38, 1.0, v38
    v_add_f32 v39, 1.0, v39
    v_rcp_f32 v36, v36
    v_rcp_f32 v37, v37
    v_rcp_f32 v38, v38
    v_rcp_f32 v39, v39
    v_mul_f32 v36, v68, v36
    v_mul_f32 v37, v69, v37
    v_mul_f32 v38, v70, v38
    v_mul_f32 v39, v71, v39
    v_cvt_pk_bf16_f32 v66, v36, v37
    v_cvt_pk_bf16_f32 v67, v38, v39
    s_waitcnt lgkmcnt(0)
    v_or_b32 v52, v52, v32
    v_or_b32 v53, v53, v33
    v_or_b32 v54, v54, v34
    v_or_b32 v55, v55, v35
    s_cmp_le_u32 s20, 16
    s_cbranch_scc1 K2_T0_HALF
    v_cvt_pk_bf16_f32 v56, v56, v57
    v_cvt_pk_bf16_f32 v57, v58, v59
    v_cvt_pk_bf16_f32 v58, v60, v61
    v_cvt_pk_bf16_f32 v59, v62, v63
    v_lshlrev_b16 v60, 1, v56
    v_lshlrev_b16_sdwa v32, 1, v56 dst_sel:DWORD dst_unused:UNUSED_PAD src0_sel:DWORD src1_sel:WORD_1
    ds_read_u16 v60, v60 offset:49024
    ds_read_u16_d16_hi v32, v32 offset:49024
    v_lshlrev_b16 v61, 1, v57
    v_lshlrev_b16_sdwa v33, 1, v57 dst_sel:DWORD dst_unused:UNUSED_PAD src0_sel:DWORD src1_sel:WORD_1
    ds_read_u16 v61, v61 offset:49024
    ds_read_u16_d16_hi v33, v33 offset:49024
    v_lshlrev_b16 v62, 1, v58
    v_lshlrev_b16_sdwa v34, 1, v58 dst_sel:DWORD dst_unused:UNUSED_PAD src0_sel:DWORD src1_sel:WORD_1
    ds_read_u16 v62, v62 offset:49024
    ds_read_u16_d16_hi v34, v34 offset:49024
    v_lshlrev_b16 v63, 1, v59
    v_lshlrev_b16_sdwa v35, 1, v59 dst_sel:DWORD dst_unused:UNUSED_PAD src0_sel:DWORD src1_sel:WORD_1
    ds_read_u16 v63, v63 offset:49024
    ds_read_u16_d16_hi v35, v35 offset:49024
    v_pk_max_i16 v56, v56, 0
    v_pk_max_i16 v57, v57, 0
    v_pk_max_i16 v58, v58, 0
    v_pk_max_i16 v59, v59, 0
    v_mfma_f32_32x32x16_bf16 v[96:111], v[48:51], v[40:43], v[96:111]
    v_mfma_f32_32x32x16_bf16 v[112:127], v[64:67], v[40:43], v[112:127]
    v_mfma_f32_32x32x16_bf16 v[96:111], v[52:55], v[40:43], v[96:111]
    s_cmp_le_u32 s20, 32
    s_cbranch_scc1 K2_T0_LASTV
    v_exp_f32 v36, v72
    v_exp_f32 v37, v73
    v_exp_f32 v38, v74
    buffer_load_dword v80, v80, s[44:47], 0 offen sc1
    v_exp_f32 v39, v75
    v_add_f32 v36, 1.0, v36
    buffer_load_dword v81, v81, s[44:47], 0 offen sc1
    v_add_f32 v37, 1.0, v37
    v_add_f32 v38, 1.0, v38
    buffer_load_dword v82, v82, s[44:47], 0 offen sc1
    v_add_f32 v39, 1.0, v39
    v_rcp_f32 v36, v36
    buffer_load_dword v83, v83, s[44:47], 0 offen sc1
    v_rcp_f32 v37, v37
    v_rcp_f32 v38, v38
    v_rcp_f32 v39, v39
    buffer_load_dword v84, v84, s[44:47], 0 offen sc1
    v_mul_f32 v36, v72, v36
    v_mul_f32 v37, v73, v37
    buffer_load_dword v85, v85, s[44:47], 0 offen sc1
    v_mul_f32 v38, v74, v38
    v_mul_f32 v39, v75, v39
    buffer_load_dword v86, v86, s[44:47], 0 offen sc1
    v_cvt_pk_bf16_f32 v72, v36, v37
    v_cvt_pk_bf16_f32 v73, v38, v39
    buffer_load_dword v87, v87, s[44:47], 0 offen sc1
    v_exp_f32 v36, v76
    v_exp_f32 v37, v77
    v_exp_f32 v38, v78
    buffer_load_dword v88, v88, s[44:47], 0 offen sc1
    v_exp_f32 v39, v79
    v_add_f32 v36, 1.0, v36
    buffer_load_dword v89, v89, s[44:47], 0 offen sc1
    v_add_f32 v37, 1.0, v37
    v_add_f32 v38, 1.0, v38
    buffer_load_dword v90, v90, s[44:47], 0 offen sc1
    v_add_f32 v39, 1.0, v39
    v_rcp_f32 v36, v36
    buffer_load_dword v91, v91, s[44:47], 0 offen sc1
    v_rcp_f32 v37, v37
    v_rcp_f32 v38, v38
    v_rcp_f32 v39, v39
    buffer_load_dword v92, v92, s[44:47], 0 offen sc1
    v_mul_f32 v36, v76, v36
    v_mul_f32 v37, v77, v37
    buffer_load_dword v93, v93, s[44:47], 0 offen sc1
    v_mul_f32 v38, v78, v38
    v_mul_f32 v39, v79, v39
    buffer_load_dword v94, v94, s[44:47], 0 offen sc1
    v_cvt_pk_bf16_f32 v74, v36, v37
    v_cvt_pk_bf16_f32 v75, v38, v39
    buffer_load_dword v95, v95, s[44:47], 0 offen sc1
    s_cmp_le_u32 s20, 64
    s_cbranch_scc1 K2_T0_NG3
    buffer_load_dwordx3 v[4:6], v4, s[48:51], 0 idxen sc1
    s_add_u32 m0, m0, 256
K2_T0_NG3:
    s_waitcnt lgkmcnt(0)
    v_or_b32 v60, v60, v32
    v_or_b32 v61, v61, v33
    v_or_b32 v62, v62, v34
    v_or_b32 v63, v63, v35
    v_mfma_f32_32x32x16_bf16 v[96:111], v[56:59], v[44:47], v[96:111]
    v_mfma_f32_32x32x16_bf16 v[112:127], v[72:75], v[44:47], v[112:127]
    v_mfma_f32_32x32x16_bf16 v[96:111], v[60:63], v[44:47], v[96:111]
    s_sub_u32 s20, s20, 32
    s_branch K2_T1
K2_T0_LASTV:
    v_exp_f32 v36, v72
    v_exp_f32 v37, v73
    v_exp_f32 v38, v74
    v_exp_f32 v39, v75
    v_add_f32 v36, 1.0, v36
    v_add_f32 v37, 1.0, v37
    v_add_f32 v38, 1.0, v38
    v_add_f32 v39, 1.0, v39
    v_rcp_f32 v36, v36
    v_rcp_f32 v37, v37
    v_rcp_f32 v38, v38
    v_rcp_f32 v39, v39
    v_mul_f32 v36, v72, v36
    v_mul_f32 v37, v73, v37
    v_mul_f32 v38, v74, v38
    v_mul_f32 v39, v75, v39
    v_cvt_pk_bf16_f32 v72, v36, v37
    v_cvt_pk_bf16_f32 v73, v38, v39
    v_exp_f32 v36, v76
    v_exp_f32 v37, v77
    v_exp_f32 v38, v78
    v_exp_f32 v39, v79
    v_add_f32 v36, 1.0, v36
    v_add_f32 v37, 1.0, v37
    v_add_f32 v38, 1.0, v38
    v_add_f32 v39, 1.0, v39
    v_rcp_f32 v36, v36
    v_rcp_f32 v37, v37
    v_rcp_f32 v38, v38
    v_rcp_f32 v39, v39
    v_mul_f32 v36, v76, v36
    v_mul_f32 v37, v77, v37
    v_mul_f32 v38, v78, v38
    v_mul_f32 v39, v79, v39
    v_cvt_pk_bf16_f32 v74, v36, v37
    v_cvt_pk_bf16_f32 v75, v38, v39
    s_waitcnt lgkmcnt(0)
    v_or_b32 v60, v60, v32
    v_or_b32 v61, v61, v33
    v_or_b32 v62, v62, v34
    v_or_b32 v63, v63, v35
    v_mfma_f32_32x32x16_bf16 v[96:111], v[56:59], v[44:47], v[96:111]
    v_mfma_f32_32x32x16_bf16 v[112:127], v[72:75], v[44:47], v[112:127]
    v_mfma_f32_32x32x16_bf16 v[96:111], v[60:63], v[44:47], v[96:111]
    s_branch K2_LOOP_DONE
K2_T0_HALF:
    v_mfma_f32_32x32x16_bf16 v[96:111], v[48:51], v[40:43], v[96:111]
    v_mfma_f32_32x32x16_bf16 v[112:127], v[64:67], v[40:43], v[112:127]
    v_mfma_f32_32x32x16_bf16 v[96:111], v[52:55], v[40:43], v[96:111]
    s_branch K2_LOOP_DONE
K2_T1:
    s_setprio 3
    s_cmp_gt_u32 s20, 160
    s_cbranch_scc1 K2_PP1
    s_setprio 2
    s_cmp_gt_u32 s20, 96
    s_cbranch_scc1 K2_PP1
    s_setprio 1
    s_cmp_gt_u32 s20, 32
    s_cbranch_scc1 K2_PP1
    s_setprio 0
K2_PP1:
    s_cmp_le_u32 s20, 32
    s_cbranch_scc1 K2_T1_NG1
    v_lshrrev_b32 v32, 4, v7
    v_and_b32 v32, 0xfe0, v32
    ds_read_b128 v[36:39], v32 offset:44944
    ds_read_b128 v[64:67], v0 offset:256
    ds_read_b128 v[68:71], v0 offset:288
    ds_read_b128 v[72:75], v0 offset:320
    ds_read_b128 v[76:79], v0 offset:352
K2_T1_NG1:
    s_mov_b64 exec, s[42:43]
    ds_write_b64 v3, v[8:9]
    s_mov_b64 exec, -1
    ds_read_b64_tr_b16 v[40:41], v2 offset:0
    ds_read_b64_tr_b16 v[42:43], v2 offset:512
    ds_read_b64_tr_b16 v[44:45], v2 offset:1024
    ds_read_b64_tr_b16 v[46:47], v2 offset:1536
    s_mov_b64 exec, s[42:43]
    ds_write_b64 v3, v[20:21]
    s_mov_b64 exec, -1
    s_waitcnt vmcnt(0)
    v_lshlrev_b32 v48, 16, v80
    v_lshlrev_b32 v49, 16, v81
    v_lshlrev_b32 v50, 16, v82
    v_lshlrev_b32 v51, 16, v83
    v_lshlrev_b32 v52, 16, v84
    v_lshlrev_b32 v53, 16, v85
    v_lshlrev_b32 v54, 16, v86
    v_lshlrev_b32 v55, 16, v87
    v_lshlrev_b32 v56, 16, v88
    v_lshlrev_b32 v57, 16, v89
    v_lshlrev_b32 v58, 16, v90
    v_lshlrev_b32 v59, 16, v91
    v_lshlrev_b32 v60, 16, v92
    v_lshlrev_b32 v61, 16, v93
    v_lshlrev_b32 v62, 16, v94
    v_lshlrev_b32 v63, 16, v95
    s_nop 1
    v_mfma_f32_32x32x16_bf16 v[48:63], v[12:15], v[16:19], v[48:63]
    v_mfma_f32_32x32x16_bf16 v[80:95], v[12:15], v[22:25], v[80:95]
    s_cmp_le_u32 s20, 32
    s_cbranch_scc1 K2_T1_NG2
    ds_read_b64 v[10:11], v32 offset:44928
    ds_read_b64 v[14:15], v32 offset:44936
    s_waitcnt lgkmcnt(12)
    v_perm_b32 v13, v7, v7, s52
    v_sub_f32 v36, v36, v4
    v_sub_f32 v37, v37, v5
    v_sub_f32 v38, v38, v6
    v_xor_b32 v3, v39, v1
    v_cvt_pk_bf16_f32 v8, v36, v37
    v_cvt_pk_bf16_f32 v9, v38, 1.0
    v_lshlrev_b32 v36, 16, v8
    v_and_b32 v37, 0xffff0000, v8
    v_lshlrev_b32 v38, 16, v9
    v_mul_f32 v36, v36, v36
    v_mul_f32 v37, v37, v37
    v_mul_f32 v38, v38, v38
    v_cvt_pk_bf16_f32 v39, v36, v37
    v_cvt_pk_bf16_f32 v38, 0, v38
    v_lshlrev_b32 v36, 16, v39
    v_and_b32 v37, 0xffff0000, v39
    v_add_f32 v36, v36, v37
    v_add_f32 v36, v36, v38
    v_cvt_pk_bf16_f32 v12, v36, v36
    s_branch K2_T1_GO
K2_T1_NG2:
    s_nop 9
K2_T1_GO:
    v_cvt_pk_bf16_f32 v48, v48, v49
    v_cvt_pk_bf16_f32 v49, v50, v51
    v_cvt_pk_bf16_f32 v50, v52, v53
    v_cvt_pk_bf16_f32 v51, v54, v55
    v_lshlrev_b16 v52, 1, v48
    v_lshlrev_b16_sdwa v32, 1, v48 dst_sel:DWORD dst_unused:UNUSED_PAD src0_sel:DWORD src1_sel:WORD_1
    ds_read_u16 v52, v52 offset:49024
    ds_read_u16_d16_hi v32, v32 offset:49024
    v_lshlrev_b16 v53, 1, v49
    v_lshlrev_b16_sdwa v33, 1, v49 dst_sel:DWORD dst_unused:UNUSED_PAD src0_sel:DWORD src1_sel:WORD_1
    ds_read_u16 v53, v53 offset:49024
    ds_read_u16_d16_hi v33, v33 offset:49024
    v_lshlrev_b16 v54, 1, v50
    v_lshlrev_b16_sdwa v34, 1, v50 dst_sel:DWORD dst_unused:UNUSED_PAD src0_sel:DWORD src1_sel:WORD_1
    ds_read_u16 v54, v54 offset:49024
    ds_read_u16_d16_hi v34, v34 offset:49024
    v_lshlrev_b16 v55, 1, v51
    v_lshlrev_b16_sdwa v35, 1, v51 dst_sel:DWORD dst_unused:UNUSED_PAD src0_sel:DWORD src1_sel:WORD_1
    ds_read_u16 v55, v55 offset:49024
    ds_read_u16_d16_hi v35, v35 offset:49024
    v_pk_max_i16 v48, v48, 0
    v_pk_max_i16 v49, v49, 0
    v_pk_max_i16 v50, v50, 0
    v_pk_max_i16 v51, v51, 0
    v_exp_f32 v36, v80
    v_exp_f32 v37, v81
    v_exp_f32 v38, v82
    v_exp_f32 v39, v83
    v_add_f32 v36, 1.0, v36
    v_add_f32 v37, 1.0, v37
    v_add_f32 v38, 1.0, v38
    v_add_f32 v39, 1.0, v39
    v_rcp_f32 v36, v36
    v_rcp_f32 v37, v37
    v_rcp_f32 v38, v38
    v_rcp_f32 v39, v39
    v_mul_f32 v36, v80, v36
    v_mul_f32 v37, v81, v37
    v_mul_f32 v38, v82, v38
    v_mul_f32 v39, v83, v39
    v_cvt_pk_bf16_f32 v80, v36, v37
    v_cvt_pk_bf16_f32 v81, v38, v39
    v_exp_f32 v36, v84
    v_exp_f32 v37, v85
    v_exp_f32 v38, v86
    v_exp_f32 v39, v87
    v_add_f32 v36, 1.0, v36
    v_add_f32 v37, 1.0, v37
    v_add_f32 v38, 1.0, v38
    v_add_f32 v39, 1.0, v39
    v_rcp_f32 v36, v36
    v_rcp_f32 v37, v37
    v_rcp_f32 v38, v38
    v_rcp_f32 v39, v39
    v_mul_f32 v36, v84, v36
    v_mul_f32 v37, v85, v37
    v_mul_f32 v38, v86, v38
    v_mul_f32 v39, v87, v39
    v_cvt_pk_bf16_f32 v82, v36, v37
    v_cvt_pk_bf16_f32 v83, v38, v39
    s_waitcnt lgkmcnt(0)
    v_or_b32 v52, v52, v32
    v_or_b32 v53, v53, v33
    v_or_b32 v54, v54, v34
    v_or_b32 v55, v55, v35
    s_cmp_le_u32 s20, 16
    s_cbranch_scc1 K2_T1_HALF
    v_cvt_pk_bf16_f32 v56, v56, v57
    v_cvt_pk_bf16_f32 v57, v58, v59
    v_cvt_pk_bf16_f32 v58, v60, v61
    v_cvt_pk_bf16_f32 v59, v62, v63
    v_lshlrev_b16 v60, 1, v56
    v_lshlrev_b16_sdwa v32, 1, v56 dst_sel:DWORD dst_unused:UNUSED_PAD src0_sel:DWORD src1_sel:WORD_1
    ds_read_u16 v60, v60 offset:49024
    ds_read_u16_d16_hi v32, v32 offset:49024
    v_lshlrev_b16 v61, 1, v57
    v_lshlrev_b16_sdwa v33, 1, v57 dst_sel:DWORD dst_unused:UNUSED_PAD src0_sel:DWORD src1_sel:WORD_1
    ds_read_u16 v61, v61 offset:49024
    ds_read_u16_d16_hi v33, v33 offset:49024
    v_lshlrev_b16 v62, 1, v58
    v_lshlrev_b16_sdwa v34, 1, v58 dst_sel:DWORD dst_unused:UNUSED_PAD src0_sel:DWORD src1_sel:WORD_1
    ds_read_u16 v62, v62 offset:49024
    ds_read_u16_d16_hi v34, v34 offset:49024
    v_lshlrev_b16 v63, 1, v59
    v_lshlrev_b16_sdwa v35, 1, v59 dst_sel:DWORD dst_unused:UNUSED_PAD src0_sel:DWORD src1_sel:WORD_1
    ds_read_u16 v63, v63 offset:49024
    ds_read_u16_d16_hi v35, v35 offset:49024
    v_pk_max_i16 v56, v56, 0
    v_pk_max_i16 v57, v57, 0
    v_pk_max_i16 v58, v58, 0
    v_pk_max_i16 v59, v59, 0
    v_mfma_f32_32x32x16_bf16 v[96:111], v[48:51], v[40:43], v[96:111]
    v_mfma_f32_32x32x16_bf16 v[112:127], v[80:83], v[40:43], v[112:127]
    v_mfma_f32_32x32x16_bf16 v[96:111], v[52:55], v[40:43], v[96:111]
    v_permlane32_swap_b32 v10, v14
    v_permlane32_swap_b32 v11, v15
    s_cmp_le_u32 s20, 32
    s_cbranch_scc1 K2_T1_LASTV
    v_exp_f32 v36, v88
    v_exp_f32 v37, v89
    v_exp_f32 v38, v90
    buffer_load_dword v64, v64, s[44:47], 0 offen sc1
    v_exp_f32 v39, v91
    v_add_f32 v36, 1.0, v36
    buffer_load_dword v65, v65, s[44:47], 0 offen sc1
    v_add_f32 v37, 1.0, v37
    v_add_f32 v38, 1.0, v38
    buffer_load_dword v66, v66, s[44:47], 0 offen sc1
    v_add_f32 v39, 1.0, v39
    v_rcp_f32 v36, v36
    buffer_load_dword v67, v67, s[44:47], 0 offen sc1
    v_rcp_f32 v37, v37
    v_rcp_f32 v38, v38
    v_rcp_f32 v39, v39
    buffer_load_dword v68, v68, s[44:47], 0 offen sc1
    v_mul_f32 v36, v88, v36
    v_mul_f32 v37, v89, v37
    buffer_load_dword v69, v69, s[44:47], 0 offen sc1
    v_mul_f32 v38, v90, v38
    v_mul_f32 v39, v91, v39
    buffer_load_dword v70, v70, s[44:47], 0 offen sc1
    v_cvt_pk_bf16_f32 v88, v36, v37
    v_cvt_pk_bf16_f32 v89, v38, v39
    buffer_load_dword v71, v71, s[44:47], 0 offen sc1
    v_exp_f32 v36, v92
    v_exp_f32 v37, v93
    v_exp_f32 v38, v94
    buffer_load_dword v72, v72, s[44:47], 0 offen sc1
    v_exp_f32 v39, v95
    v_add_f32 v36, 1.0, v36
    buffer_load_dword v73, v73, s[44:47], 0 offen sc1
    v_add_f32 v37, 1.0, v37
    v_add_f32 v38, 1.0, v38
    buffer_load_dword v74, v74, s[44:47], 0 offen sc1
    v_add_f32 v39, 1.0, v39
    v_rcp_f32 v36, v36
    buffer_load_dword v75, v75, s[44:47], 0 offen sc1
    v_rcp_f32 v37, v37
    v_rcp_f32 v38, v38
    v_rcp_f32 v39, v39
    buffer_load_dword v76, v76, s[44:47], 0 offen sc1
    v_mul_f32 v36, v92, v36
    v_mul_f32 v37, v93, v37
    buffer_load_dword v77, v77, s[44:47], 0 offen sc1
    v_mul_f32 v38, v94, v38
    v_mul_f32 v39, v95, v39
    buffer_load_dword v78, v78, s[44:47], 0 offen sc1
    v_cvt_pk_bf16_f32 v90, v36, v37
    v_cvt_pk_bf16_f32 v91, v38, v39
    buffer_load_dword v79, v79, s[44:47], 0 offen sc1
    s_waitcnt lgkmcnt(0)
    v_or_b32 v60, v60, v32
    v_or_b32 v61, v61, v33
    v_or_b32 v62, v62, v34
    v_or_b32 v63, v63, v35
    v_mfma_f32_32x32x16_bf16 v[96:111], v[56:59], v[44:47], v[96:111]
    v_mfma_f32_32x32x16_bf16 v[112:127], v[88:91], v[44:47], v[112:127]
    v_mfma_f32_32x32x16_bf16 v[96:111], v[60:63], v[44:47], v[96:111]
    s_sub_u32 s20, s20, 32
    v_add_u32 v0, 256, v0
    s_bfm_b64 s[56:57], s20, 0
    s_cmp_ge_u32 s20, 64
    s_cselect_b32 s40, -1, s56
    s_cselect_b32 s43, -1, s57
    s_branch K2_T0
K2_T1_LASTV:
    v_exp_f32 v36, v88
    v_exp_f32 v37, v89
    v_exp_f32 v38, v90
    v_exp_f32 v39, v91
    v_add_f32 v36, 1.0, v36
    v_add_f32 v37, 1.0, v37
    v_add_f32 v38, 1.0, v38
    v_add_f32 v39, 1.0, v39
    v_rcp_f32 v36, v36
    v_rcp_f32 v37, v37
    v_rcp_f32 v38, v38
    v_rcp_f32 v39, v39
    v_mul_f32 v36, v88, v36
    v_mul_f32 v37, v89, v37
    v_mul_f32 v38, v90, v38
    v_mul_f32 v39, v91, v39
    v_cvt_pk_bf16_f32 v88, v36, v37
    v_cvt_pk_bf16_f32 v89, v38, v39
    v_exp_f32 v36, v92
    v_exp_f32 v37, v93
    v_exp_f32 v38, v94
    v_exp_f32 v39, v95
    v_add_f32 v36, 1.0, v36
    v_add_f32 v37, 1.0, v37
    v_add_f32 v38, 1.0, v38
    v_add_f32 v39, 1.0, v39
    v_rcp_f32 v36, v36
    v_rcp_f32 v37, v37
    v_rcp_f32 v38, v38
    v_rcp_f32 v39, v39
    v_mul_f32 v36, v92, v36
    v_mul_f32 v37, v93, v37
    v_mul_f32 v38, v94, v38
    v_mul_f32 v39, v95, v39
    v_cvt_pk_bf16_f32 v90, v36, v37
    v_cvt_pk_bf16_f32 v91, v38, v39
    s_waitcnt lgkmcnt(0)
    v_or_b32 v60, v60, v32
    v_or_b32 v61, v61, v33
    v_or_b32 v62, v62, v34
    v_or_b32 v63, v63, v35
    v_mfma_f32_32x32x16_bf16 v[96:111], v[56:59], v[44:47], v[96:111]
    v_mfma_f32_32x32x16_bf16 v[112:127], v[88:91], v[44:47], v[112:127]
    v_mfma_f32_32x32x16_bf16 v[96:111], v[60:63], v[44:47], v[96:111]
    s_branch K2_LOOP_DONE
K2_T1_HALF:
    v_mfma_f32_32x32x16_bf16 v[96:111], v[48:51], v[40:43], v[96:111]
    v_mfma_f32_32x32x16_bf16 v[112:127], v[80:83], v[40:43], v[112:127]
    v_mfma_f32_32x32x16_bf16 v[96:111], v[52:55], v[40:43], v[96:111]
    s_branch K2_LOOP_DONE
K2_SLOW:
    s_mov_b32 s21, -1
    s_mov_b32 s22, 2
K2_ROUND:
    s_setprio 0
    s_waitcnt vmcnt(0) lgkmcnt(0)
    s_barrier
    v_mbcnt_lo_u32_b32 v60, -1, 0
    v_mbcnt_hi_u32_b32 v60, -1, v60
    v_lshlrev_b32 v50, 2, v60
    v_and_b32 v51, 63, v50
    s_cmp_lg_u32 s19, 0
    s_cbranch_scc1 K2_NOCNT2
    ds_read_b32 v33, v51 offset:35840
    v_mov_b32 v34, 0
    s_waitcnt lgkmcnt(0)
    ds_write_b32 v51, v33 offset:35584
    ds_write_b32 v51, v34 offset:35648
K2_NOCNT2:
    s_mul_i32 s3, s18, 32896
    s_lshl_b32 s54, s19, 11
    s_add_u32 s3, s3, s54
    s_add_u32 s3, s3, 4194304
    v_lshl_add_u32 v52, v60, 4, s3
    s_mul_i32 s3, s19, 401408
    s_add_u32 s3, s3, 15728640
    v_and_b32 v53, 7, v60
    v_lshl_add_u32 v53, v53, 4, s3
    v_lshrrev_b32 v54, 3, v60
    s_movk_i32 s3, 25088
    v_mad_u32_u24 v53, v54, s3, v53
    global_load_dwordx4 v[80:83], v52, s[16:17] sc1
    global_load_dwordx4 v[84:87], v52, s[16:17] offset:1024 sc1
    s_and_b32 s55, s22, 1
    s_xor_b32 s55, s55, 1
    s_add_u32 s21, s21, s55
    s_waitcnt vmcnt(0) lgkmcnt(0)
    s_barrier
    v_bfe_u32 v54, v81, 1, 8
    v_bfe_u32 v55, v85, 1, 8
    v_bfe_u32 v56, v83, 1, 8
    v_bfe_u32 v57, v87, 1, 8
    v_cmp_le_u32 s[78:79], s21, v54
    v_cmp_le_u32 s[80:81], s21, v55
    v_max_u32 v54, v54, v55
    v_cmp_lt_u32 s[58:59], s21, v54
    s_cmp_eq_u32 s21, 0
    s_cbranch_scc1 K2_LEV0
    s_sub_u32 s3, s21, 1
    v_add_u32 v56, s3, v56
    v_add_u32 v57, s3, v57
    v_lshl_add_u32 v56, v56, 7, v53
    v_lshl_add_u32 v57, v57, 7, v53
    v_add_u32 v57, 200704, v57
    s_mov_b64 exec, s[78:79]
    global_load_dwordx4 v[80:83], v56, s[16:17] sc1
    s_mov_b64 exec, s[80:81]
    global_load_dwordx4 v[84:87], v57, s[16:17] sc1
    s_mov_b64 exec, -1
    s_waitcnt vmcnt(0)
K2_LEV0:
    v_xor_b32 v80, s72, v80
    v_xor_b32 v82, s72, v82
    v_xor_b32 v84, s72, v84
    v_xor_b32 v86, s72, v86
    s_bitcmp1_b32 s22, 0
    s_cbranch_scc1 K2_KEEPM
    v_cmp_ne_u32 vcc, 0, v81
    s_nop 0
    s_and_b64 s[24:25], vcc, s[78:79]
    v_cmp_ne_u32 vcc, 0, v83
    s_nop 0
    s_and_b64 s[26:27], vcc, s[78:79]
    v_cmp_ne_u32 vcc, 0, v85
    s_nop 0
    s_and_b64 s[28:29], vcc, s[80:81]
    v_cmp_ne_u32 vcc, 0, v87
    s_nop 0
    s_and_b64 s[30:31], vcc, s[80:81]
K2_KEEPM:
    v_mov_b32 v48, 4
    v_mov_b32 v49, 0
    s_mov_b64 s[56:57], 0
    s_mov_b64 exec, s[24:25]
    v_lshrrev_b32 v64, 10, v81
    v_and_b32 v64, 0x3c, v64
    ds_read_b32 v65, v64 offset:35776
    ds_add_rtn_u32 v64, v64, v48 offset:35584
    s_waitcnt lgkmcnt(0)
    v_cmp_lt_u32 vcc, v64, v65
    s_nop 0
    s_andn2_b64 s[24:25], exec, vcc
    s_mov_b64 exec, vcc
    ds_write_b32 v64, v80 offset:0
    ds_write_b32 v64, v81 offset:17792
    s_or_b64 s[56:57], s[56:57], s[24:25]
    s_mov_b64 exec, s[26:27]
    v_lshrrev_b32 v64, 10, v83
    v_and_b32 v64, 0x3c, v64
    ds_read_b32 v65, v64 offset:35776
    ds_add_rtn_u32 v64, v64, v48 offset:35584
    s_waitcnt lgkmcnt(0)
    v_cmp_lt_u32 vcc, v64, v65
    s_nop 0
    s_andn2_b64 s[26:27], exec, vcc
    s_mov_b64 exec, vcc
    ds_write_b32 v64, v82 offset:0
    ds_write_b32 v64, v83 offset:17792
    s_or_b64 s[56:57], s[56:57], s[26:27]
    s_mov_b64 exec, s[28:29]
    v_lshrrev_b32 v64, 10, v85
    v_and_b32 v64, 0x3c, v64
    ds_read_b32 v65, v64 offset:35776
    ds_add_rtn_u32 v64, v64, v48 offset:35584
    s_waitcnt lgkmcnt(0)
    v_cmp_lt_u32 vcc, v64, v65
    s_nop 0
    s_andn2_b64 s[28:29], exec, vcc
    s_mov_b64 exec, vcc
    ds_write_b32 v64, v84 offset:0
    ds_write_b32 v64, v85 offset:17792
    s_or_b64 s[56:57], s[56:57], s[28:29]
    s_mov_b64 exec, s[30:31]
    v_lshrrev_b32 v64, 10, v87
    v_and_b32 v64, 0x3c, v64
    ds_read_b32 v65, v64 offset:35776
    ds_add_rtn_u32 v64, v64, v48 offset:35584
    s_waitcnt lgkmcnt(0)
    v_cmp_lt_u32 vcc, v64, v65
    s_nop 0
    s_andn2_b64 s[30:31], exec, vcc
    s_mov_b64 exec, vcc
    ds_write_b32 v64, v86 offset:0
    ds_write_b32 v64, v87 offset:17792
    s_or_b64 s[56:57], s[56:57], s[30:31]
    s_mov_b64 exec, s[56:57]
    s_cbranch_execz K2_NOF1
    ds_write_b32 v49, v48 offset:35648
K2_NOF1:
    s_mov_b64 exec, s[58:59]
    s_cbranch_execz K2_NOF2
    ds_write_b32 v49, v48 offset:35652
K2_NOF2:
    s_mov_b64 exec, -1
    s_waitcnt lgkmcnt(0)
    s_barrier
    ds_read_b32 v33, v50 offset:35584
    ds_read_b32 v34, v51 offset:35776
    v_lshrrev_b32 v0, 5, v60
    v_lshl_add_u32 v0, v0, 4, s53
    v_mov_b32 v12, 0
    s_waitcnt lgkmcnt(0)
    v_readlane_b32 s54, v33, 16
    v_readlane_b32 s55, v33, 17
    v_min_u32 v33, v33, v34
    s_cmp_lg_u32 s54, 0
    s_cselect_b32 s22, 1, 0
    s_cmp_lg_u32 s55, 0
    s_cselect_b32 s55, 2, 0
    s_or_b32 s22, s22, s55
    v_readlane_b32 s20, v33, s73
    s_nop 1
    s_branch K2_START
K2_LOOP_DONE:
    s_cmp_lg_u32 s22, 0
    s_cbranch_scc1 K2_ROUND
    v_mbcnt_lo_u32_b32 v4, -1, 0
    v_mbcnt_hi_u32_b32 v4, -1, v4
    v_and_b32 v5, 31, v4
    v_lshrrev_b32 v6, 5, v4
    v_bfe_u32 v7, v4, 2, 2
    v_lshl_add_u32 v7, v6, 2, v7
    v_and_b32 v3, 3, v4
    v_lshl_add_u32 v7, v7, 3, v3
    v_bfe_u32 v8, v4, 4, 1
    v_lshl_add_u32 v7, v8, 2, v7
    v_lshlrev_b32 v7, 3, v7
    ds_read_b64_tr_b16 v[64:65], v7 offset:36736
    ds_read_b64_tr_b16 v[66:67], v7 offset:37248
    ds_read_b64_tr_b16 v[68:69], v7 offset:40832
    ds_read_b64_tr_b16 v[70:71], v7 offset:41344
    ds_read_b64_tr_b16 v[72:73], v7 offset:37760
    ds_read_b64_tr_b16 v[74:75], v7 offset:38272
    ds_read_b64_tr_b16 v[76:77], v7 offset:41856
    ds_read_b64_tr_b16 v[78:79], v7 offset:42368
    ds_read_b64_tr_b16 v[80:81], v7 offset:38784
    ds_read_b64_tr_b16 v[82:83], v7 offset:39296
    ds_read_b64_tr_b16 v[84:85], v7 offset:42880
    ds_read_b64_tr_b16 v[86:87], v7 offset:43392
    ds_read_b64_tr_b16 v[88:89], v7 offset:39808
    ds_read_b64_tr_b16 v[90:91], v7 offset:40320
    ds_read_b64_tr_b16 v[92:93], v7 offset:43904
    ds_read_b64_tr_b16 v[94:95], v7 offset:44416
    v_lshlrev_b32 v8, 4, v6
    ds_read_b128 v[12:15], v8 offset:36032
    ds_read_b128 v[16:19], v8 offset:36064
    ds_read_b128 v[20:23], v8 offset:36096
    ds_read_b128 v[24:27], v8 offset:36128
    v_lshrrev_b32 v9, 2, v5
    s_lshl_b32 s54, s73, 8
    v_lshl_add_u32 v10, v9, 5, s54
    v_lshl_add_u32 v9, v9, 4, s73
    v_lshl_add_u32 v11, v6, 3, v10
    v_lshl_add_u32 v10, v3, 2, v10
    ds_read_b64 v[0:1], v11 offset:44928
    ds_read_b32 v2, v10 offset:44944
    s_mov_b32 s56, 0xbf317218
    s_mov_b32 s57, 0xbf317218
    v_pk_mul_f32 v[112:113], v[112:113], s[56:57]
    v_pk_mul_f32 v[114:115], v[114:115], s[56:57]
    v_pk_mul_f32 v[116:117], v[116:117], s[56:57]
    v_pk_mul_f32 v[118:119], v[118:119], s[56:57]
    v_pk_mul_f32 v[120:121], v[120:121], s[56:57]
    v_pk_mul_f32 v[122:123], v[122:123], s[56:57]
    v_pk_mul_f32 v[124:125], v[124:125], s[56:57]
    v_pk_mul_f32 v[126:127], v[126:127], s[56:57]
    v_cvt_pk_bf16_f32 v32, v96, v97
    v_cvt_pk_bf16_f32 v33, v98, v99
    v_cvt_pk_bf16_f32 v34, v100, v101
    v_cvt_pk_bf16_f32 v35, v102, v103
    v_cvt_pk_bf16_f32 v36, v104, v105
    v_cvt_pk_bf16_f32 v37, v106, v107
    v_cvt_pk_bf16_f32 v38, v108, v109
    v_cvt_pk_bf16_f32 v39, v110, v111
    v_cvt_pk_bf16_f32 v40, v112, v113
    v_cvt_pk_bf16_f32 v41, v114, v115
    v_cvt_pk_bf16_f32 v42, v116, v117
    v_cvt_pk_bf16_f32 v43, v118, v119
    v_cvt_pk_bf16_f32 v44, v120, v121
    v_cvt_pk_bf16_f32 v45, v122, v123
    v_cvt_pk_bf16_f32 v46, v124, v125
    v_cvt_pk_bf16_f32 v47, v126, v127
    s_waitcnt lgkmcnt(0)
    v_mfma_f32_32x32x8bf16_1k v[96:111], v[0:1], v[28:29], 0
    v_mfma_f32_32x32x8bf16_1k v[112:127], v[0:1], v[30:31], 0
    s_and_b32 s55, s73, 7
    s_lshl_b32 s55, s55, 4
    s_lshl_b32 s54, s73, 7
    s_add_u32 s54, s54, 114560
    v_lshlrev_b32 v10, 2, v5
    v_xor_b32 v11, s55, v10
    v_lshl_add_u32 v11, v6, 11, v11
    v_add_u32 v11, s54, v11
    v_mfma_f32_32x32x16_bf16 v[96:111], v[32:35], v[64:67], v[96:111]
    v_mfma_f32_32x32x16_bf16 v[112:127], v[32:35], v[68:71], v[112:127]
    ds_read_b32 v28, v11 offset:0
    v_mfma_f32_32x32x16_bf16 v[96:111], v[36:39], v[72:75], v[96:111]
    v_mfma_f32_32x32x16_bf16 v[112:127], v[36:39], v[76:79], v[112:127]
    ds_read_b32 v29, v11 offset:4096
    v_mfma_f32_32x32x16_bf16 v[96:111], v[40:43], v[80:83], v[96:111]
    v_mfma_f32_32x32x16_bf16 v[112:127], v[40:43], v[84:87], v[112:127]
    ds_read_b32 v30, v11 offset:8192
    v_mfma_f32_32x32x16_bf16 v[96:111], v[44:47], v[88:91], v[96:111]
    v_mfma_f32_32x32x16_bf16 v[112:127], v[44:47], v[92:95], v[112:127]
    ds_read_b32 v31, v11 offset:12288
    s_mov_b32 s60, s14
    s_mov_b32 s61, s15
    s_mov_b32 s62, 3200000
    s_mov_b32 s63, 0x20000
    s_lshl_b32 s54, s23, 7
    v_lshl_add_u32 v10, v6, 11, v10
    v_add_u32 v10, s54, v10
    s_mov_b32 s55, 98
    v_cmp_gt_u32 s[56:57], s55, v9
    s_mul_i32 s55, s18, 98
    v_add_u32 v9, s55, v9
    v_cmp_gt_u32 vcc, 25000, v9
    s_nop 0
    s_and_b32 s56, s56, vcc_lo
    s_and_b32 s56, s56, 0x77777777
    s_mov_b32 s57, 0
    v_mul_u32_u24 v9, 6, v9
    v_lshl_add_u32 v9, v3, 1, v9
    v_add_u32 v9, 3200000, v9
    v_mfma_f32_32x32x16_bf16 v[48:63], v[12:15], v[32:35], 0
    v_mul_f32 v64, 0xbfb8aa3b, v99
    v_mul_f32 v65, 0xbfb8aa3b, v115
    v_mul_f32 v66, 0xbfb8aa3b, v103
    v_mul_f32 v67, 0xbfb8aa3b, v119
    v_mul_f32 v68, 0xbfb8aa3b, v107
    v_mul_f32 v69, 0xbfb8aa3b, v123
    v_mul_f32 v70, 0xbfb8aa3b, v111
    v_mul_f32 v71, 0xbfb8aa3b, v127
    v_mfma_f32_32x32x16_bf16 v[48:63], v[16:19], v[36:39], v[48:63]
    v_exp_f32 v64, v64
    v_exp_f32 v65, v65
    v_exp_f32 v66, v66
    v_exp_f32 v67, v67
    v_mfma_f32_32x32x16_bf16 v[48:63], v[20:23], v[40:43], v[48:63]
    v_exp_f32 v68, v68
    v_exp_f32 v69, v69
    v_exp_f32 v70, v70
    v_exp_f32 v71, v71
    v_mfma_f32_32x32x16_bf16 v[48:63], v[24:27], v[44:47], v[48:63]
    v_pk_add_f32 v[64:65], v[64:65], 1.0 op_sel_hi:[1,0]
    v_pk_add_f32 v[66:67], v[66:67], 1.0 op_sel_hi:[1,0]
    v_pk_add_f32 v[68:69], v[68:69], 1.0 op_sel_hi:[1,0]
    v_pk_add_f32 v[70:71], v[70:71], 1.0 op_sel_hi:[1,0]
    v_rcp_f32 v64, v64
    v_rcp_f32 v65, v65
    v_rcp_f32 v66, v66
    v_rcp_f32 v67, v67
    v_rcp_f32 v68, v68
    v_rcp_f32 v69, v69
    v_rcp_f32 v70, v70
    v_rcp_f32 v71, v71
    s_waitcnt lgkmcnt(0)
    v_lshlrev_b32 v72, 16, v28
    v_and_b32 v73, 0xffff0000, v28
    v_lshlrev_b32 v74, 16, v29
    v_and_b32 v75, 0xffff0000, v29
    v_lshlrev_b32 v76, 16, v30
    v_and_b32 v77, 0xffff0000, v30
    v_lshlrev_b32 v78, 16, v31
    v_and_b32 v79, 0xffff0000, v31
    v_fmac_f32 v72, v99, v64
    v_fmac_f32 v73, v115, v65
    v_fmac_f32 v74, v103, v66
    v_fmac_f32 v75, v119, v67
    v_fmac_f32 v76, v107, v68
    v_fmac_f32 v77, v123, v69
    v_fmac_f32 v78, v111, v70
    v_fmac_f32 v79, v127, v71
    v_add_f32 v2, v2, v48
    v_cvt_pk_bf16_f32 v28, v72, v73
    v_cvt_pk_bf16_f32 v29, v74, v75
    v_cvt_pk_bf16_f32 v30, v76, v77
    v_cvt_pk_bf16_f32 v31, v78, v79
    v_cvt_pk_bf16_f32 v2, v2, v2
    s_movk_i32 s24, 0x1000
    s_movk_i32 s25, 0x2000
    s_movk_i32 s26, 0x3000
    buffer_store_dword v28, v10, s[60:63], 0 offen sc1
    buffer_store_dword v29, v10, s[60:63], s24 offen sc1
    buffer_store_dword v30, v10, s[60:63], s25 offen sc1
    s_mov_b64 exec, s[56:57]
    s_cbranch_execz K2_NOPOS
    global_store_short v9, v2, s[14:15] sc1
K2_NOPOS:
    s_cmp_ge_u32 s73, 2
    s_cbranch_scc1 K2_FIN
    s_mov_b64 exec, 0xffffffff
    buffer_store_dword v31, v10, s[60:63], s26 offen sc1
K2_FIN:
K2_END:
    s_endpgm
.section .rodata,"a"
.p2align 6
.amdhsa_kernel standalone__cheap_equivariant_egnn__graph_kernel
  .amdhsa_next_free_vgpr 128
  .amdhsa_next_free_sgpr 96
  .amdhsa_accum_offset 128
  .amdhsa_group_segment_fixed_size 0
  .amdhsa_kernarg_size 88
  .amdhsa_user_sgpr_count 2
  .amdhsa_user_sgpr_kernarg_segment_ptr 1
  .amdhsa_system_sgpr_workgroup_id_x 1
  .amdhsa_float_denorm_mode_32 3
.end_amdhsa_kernel
```
